```python
import torch

def _softmax(x, axis=-1):
    return torch.softmax(x, dim=axis)
def _gelu(x):
    return torch.nn.functional.gelu(x, approximate="tanh")
def _silu(x):
    return torch.nn.functional.silu(x)
def _sigmoid(x):
    return torch.sigmoid(x)
def _layernorm(x, axis=-1, eps=1e-5):
    m = x.mean(dim=axis, keepdim=True)
    v = x.var(dim=axis, keepdim=True, unbiased=False)
    return (x - m) / torch.sqrt(v + eps)
def _scatter_add(tgt, idx, src, axis=0):
    return tgt.clone().index_add_(axis, idx, src)
def _segment_sum(src, seg, n):
    out = torch.zeros((n,) + src.shape[1:], dtype=src.dtype)
    return out.index_add_(0, seg, src)
def _pad(x, pw):
    flat = tuple(v for pair in reversed(pw) for v in pair)
    return torch.nn.functional.pad(x, flat)

kernel_name = 'gated_mix__ssm_conv_h3__dense_activation_gelu__prompt'

def setup_inputs():

    _w = (lambda a: (lambda t: t.to(torch.bfloat16) if t.is_floating_point() else t)(torch.as_tensor(a)))
    def _A_setup():
        B, S, D = 1, 2048, 512
        ks = 4
        return {
            "q": _w((lambda *s: torch.randn(*s, dtype=torch.bfloat16) * 0.05)(B, S, D)),
            "k": _w((lambda *s: torch.randn(*s, dtype=torch.bfloat16) * 0.2)(B, S, D)),
            "v": _w((lambda *s: torch.randn(*s, dtype=torch.bfloat16) * 0.2)(B, S, D)),
            "shift_k": _w((lambda *s: torch.randn(*s, dtype=torch.bfloat16) * 0.2)(D, ks) * 0.5),
            "ssm_k": _w((lambda *s: torch.randn(*s, dtype=torch.bfloat16) * 0.8)(D, S) * (1.0 / S ** 0.5)),
            "ssm_D": _w((lambda *s: torch.randn(*s, dtype=torch.bfloat16) * 0.2)(D)),
        }
    _A_in = _A_setup()

    def _B_setup():
        B, S, D, F = 1, 2048, 512, 1376
        return {
            "x": _w((lambda *s: torch.randn(*s, dtype=torch.bfloat16) * 0.05)(B, S, D)),
            "w1": _w((lambda *s: torch.randn(*s, dtype=torch.bfloat16) * 3.2)(D, F) * (D ** -0.5)),
            "b1": _w((lambda *s: torch.randn(*s, dtype=torch.bfloat16) * 3.2)(F) * 0.01),
            "w2": _w((lambda *s: torch.randn(*s, dtype=torch.bfloat16) * 0.05)(F, D) * (F ** -0.5)),
            "b2": _w((lambda *s: torch.randn(*s, dtype=torch.bfloat16) * 0.1)(D) * 0.01),
        }
    _B_in = _B_setup()

    return {
        "A_q": _A_in["q"],
        "A_k": _A_in["k"],
        "A_v": _A_in["v"],
        "A_shift_k": _A_in["shift_k"],
        "A_ssm_k": _A_in["ssm_k"],
        "A_ssm_D": _A_in["ssm_D"],
        "B_x": _B_in["x"],
        "B_w1": _B_in["w1"],
        "B_b1": _B_in["b1"],
        "B_w2": _B_in["w2"],
        "B_b2": _B_in["b2"],
        "gate_w": _w((lambda *s: torch.randn(*s, dtype=torch.bfloat16) * 0.05)(512) * 16.0),
    }

def reference(A_q, A_k, A_v, A_shift_k, A_ssm_k, A_ssm_D, B_x, B_w1, B_b1, B_w2, B_b2, gate_w):
    def _A_ref(q, k, v, shift_k, ssm_k, ssm_D):
        B, S, D = q.shape
        ks = shift_k.shape[-1]
        k_pad = _pad(k, ((0, 0), (ks - 1, 0), (0, 0)))
        k_shift = torch.zeros_like(k)
        for t in range(ks):
            k_shift = k_shift + k_pad[:, t:t + S, :] * shift_k[:, ks - 1 - t][None, None, :]
        kv = k_shift * v
        L = 2 * S
        kv_pad = _pad(kv, ((0, 0), (0, S), (0, 0)))
        kf_pad = _pad(ssm_k, ((0, 0), (0, S)))
        kv_f = (lambda x, axes=(-2,-1): torch.fft.rfft2(x.float(), dim=axes))(kv_pad[:, None, :, :], axes=(1, 2))
        kf_f = (lambda x, axes=(-2,-1): torch.fft.rfft2(x.float(), dim=axes))(kf_pad[:, None, :], axes=(1, 2))
        kf_f = (lambda x, *d: x.permute(*d))(kf_f, 1, 2, 0)
        y_f = kv_f * kf_f[None, :, :, :]
        y = (lambda x, s, axes=(-2,-1): torch.fft.irfft2(x, s=s, dim=axes).to(torch.bfloat16))(y_f, (1, L), axes=(1, 2))[:, 0, :S, :]
        y = y + kv * ssm_D[None, None, :]
        return q * y

    def _B_ref(x, w1, b1, w2, b2):
        h = torch.einsum("bsd,df->bsf", x, w1) + b1
        h = _gelu(h)
        return torch.einsum("bsf,fd->bsd", h, w2) + b2

    x = A_q
    g = _sigmoid((x * gate_w).sum(-1, keepdims=True))
    a = _A_ref(x, A_k, A_v, A_shift_k, A_ssm_k, A_ssm_D)
    b = _B_ref(x, B_w1, B_b1, B_w2, B_b2)
    return g * a + (1 - g) * b
```

```asm
; @launch grid=(256,1,1) block=(1024,1,1) lds=163840
.amdgcn_target "amdgcn-amd-amdhsa--gfx950"
.text
.globl gated_mix__ssm_conv_h3__dense_activation_gelu__prompt_kernel
.p2align 8
.type gated_mix__ssm_conv_h3__dense_activation_gelu__prompt_kernel,@function
gated_mix__ssm_conv_h3__dense_activation_gelu__prompt_kernel:
    s_cmp_ge_u32 s2, 256
    s_cbranch_scc1 L_end
    s_load_dwordx2 s[8:9], s[0:1], 0
    s_load_dwordx2 s[28:29], s[0:1], 56
    s_load_dwordx8 s[88:95], s[0:1], 8
    s_load_dwordx2 s[32:33], s[0:1], 64
    v_lshrrev_b32 v2, 6, v0
    v_and_b32 v1, 63, v0
    s_and_b32 s4, s2, 7
    v_readfirstlane_b32 s3, v2
    s_lshr_b32 s5, s2, 3
    v_lshrrev_b32 v2, 3, v1
    v_and_b32 v3, 7, v1
    s_cmp_ge_u32 s3, 2
    s_cbranch_scc1 L_rest
    s_setprio 3
    s_lshr_b32 s63, s5, 4
    s_lshl1_add_u32 s6, s4, s63
    s_and_b32 s7, s5, 15
    s_lshl_b32 s10, 1, 21
    s_mov_b32 s11, 0x20000
    s_add_u32 s61, s7, s4
    s_and_b32 s61, s61, 7
    v_lshrrev_b32 v6, 4, v1
    v_xor_b32 v5, v6, v3
    v_lshlrev_b32 v5, 4, v5
    v_lshl_add_u32 v10, v2, 10, v5
    v_xor_b32 v5, 64, v10
    v_add_u32 v11, 7168, v5
    v_add_u32 v12, 14336, v10
    v_add_u32 v13, 21504, v5
    s_lshl_b32 s67, s3, 13
    s_lshl1_add_u32 s25, s6, s3
    s_lshl_b32 s25, s25, 16
    s_lshl_b32 s65, s61, 7
    s_add_u32 m0, s67, 0
    s_add_u32 s65, s65, s25
    s_waitcnt lgkmcnt(0)
    buffer_load_dwordx4 v10, s[8:11], s65 offen offset:0 lds
    buffer_load_dwordx4 v11, s[8:11], s65 offen offset:1024 lds
    buffer_load_dwordx4 v12, s[8:11], s65 offen offset:2048 lds
    buffer_load_dwordx4 v13, s[8:11], s65 offen offset:3072 lds
    s_add_u32 m0, s67, 4096
    s_add_u32 s65, s65, 32768
    buffer_load_dwordx4 v10, s[8:11], s65 offen offset:0 lds
    buffer_load_dwordx4 v11, s[8:11], s65 offen offset:1024 lds
    buffer_load_dwordx4 v12, s[8:11], s65 offen offset:2048 lds
    buffer_load_dwordx4 v13, s[8:11], s65 offen offset:3072 lds
    s_branch L_dma2
L_rest:
    s_cmp_lt_u32 s3, 4
    s_cbranch_scc1 L_service
    s_getpc_b64 s[40:41]
L_pc0:
    v_subrev_u32 v4, 256, v0
    v_lshlrev_b32 v4, 6, v4
    v_cmp_gt_u32 vcc, L_codeend-L_pc0, v4
    s_cmp_lt_u32 s2, 32
    s_cselect_b64 exec, vcc, 0
    s_cbranch_execz L_nocpf
    global_load_dword v127, v4, s[40:41]
L_nocpf:
    s_mov_b64 exec, -1
    s_cmp_lt_u32 s3, 8
    s_cbranch_scc1 L_conv
    s_branch L_gemm
L_dma2:
    s_mov_b32 s30, 1409024
    s_mov_b32 s31, s11
    v_lshlrev_b32 v8, 4, v1
    v_lshrrev_b32 v4, 2, v1
    v_mul_u32_u24 v4, 11, v4
    s_movk_i32 s64, 2560
    v_lshrrev_b32 v5, 5, v4
    v_mad_u32_u24 v26, v5, s64, v8
    v_add_u32 v5, 11, v4
    v_lshrrev_b32 v5, 5, v5
    v_and_b32 v6, 32, v1
    v_xor_b32 v6, v6, v8
    v_mad_u32_u24 v27, v5, s64, v6
    v_add_u32 v5, 22, v4
    v_lshrrev_b32 v5, 5, v5
    v_xor_b32 v6, 32, v8
    v_mad_u32_u24 v28, v5, s64, v6
    v_add_u32 v27, 12800, v27
    v_add_u32 v28, 25600, v28
    s_mul_i32 s24, s7, 192
    s_mul_i32 s64, s3, 88064
    s_add_u32 s24, s24, s64
    s_mul_i32 s68, s3, 6144
    s_cmp_ge_u32 s7, 14
    s_cbranch_scc1 L_dma_special
L_dma_go:
    s_mul_i32 s65, s61, 176128
    s_add_u32 m0, s68, 16384
    s_add_u32 s65, s65, s24
    buffer_load_dwordx4 v26, s[28:31], s65 offen offset:0 lds
    buffer_load_dwordx4 v27, s[28:31], s65 offen offset:1024 lds
    buffer_load_dwordx4 v28, s[28:31], s65 offen offset:2048 lds
    s_add_u32 m0, s68, 19456
    s_add_u32 s65, s65, 44032
    buffer_load_dwordx4 v26, s[28:31], s65 offen offset:0 lds
    buffer_load_dwordx4 v27, s[28:31], s65 offen offset:1024 lds
    buffer_load_dwordx4 v28, s[28:31], s65 offen offset:2048 lds
    s_add_u32 s61, s61, 1
    s_and_b32 s61, s61, 7
    s_setprio 0
    s_load_dwordx2 s[36:37], s[0:1], 72
    s_mov_b32 s38, 1409024
    s_mov_b32 s39, 0x20000
    s_lshl_b32 s64, s7, 2
    s_mov_b32 s100, 0x87654210
    s_mov_b32 s101, 0xb3fedca9
    s_lshr_b64 s[100:101], s[100:101], s64
    s_and_b32 s56, s100, 7
    v_bfe_u32 v4, v1, 4, 1
    v_lshlrev_b32 v5, 2, v4
    v_xor_b32 v5, v5, v3
    v_lshlrev_b32 v5, 4, v5
    v_lshl_add_u32 v16, v2, 10, v5
    s_lshl_b32 s63, s3, 15
    s_lshl_b32 s64, s56, 7
    s_add_u32 s63, s63, s64
    v_add_u32 v16, s63, v16
    v_xor_b32 v5, 32, v16
    v_add_u32 v17, 7168, v5
    v_add_u32 v18, 14336, v16
    v_add_u32 v19, 21504, v5
    v_add_u32 v20, 65536, v16
    v_add_u32 v21, 72704, v5
    v_add_u32 v22, 79872, v16
    v_add_u32 v23, 87040, v5
    s_lshl_b32 s69, s3, 12
    s_add_u32 s63, s69, 114688
    v_add_u32 v30, s63, v8
    v_mov_b32 v9, 159744
    s_mov_b32 s63, s4
    s_sub_u32 s64, s63, 10
    s_cmp_ge_u32 s63, 10
    s_cselect_b32 s63, s64, s63
    s_sub_u32 s64, s63, 10
    s_cmp_ge_u32 s63, 10
    s_cselect_b32 s63, s64, s63
    s_lshl_b32 s40, s63, 17
    s_add_u32 s63, s63, 1
    s_cmp_eq_u32 s63, 10
    s_cselect_b32 s63, 0, s63
    s_lshl_b32 s41, s63, 17
    s_add_u32 s63, s63, 1
    s_cmp_eq_u32 s63, 10
    s_cselect_b32 s63, 0, s63
    s_lshl_b32 s42, s63, 17
    s_add_u32 s63, s63, 1
    s_cmp_eq_u32 s63, 10
    s_cselect_b32 s63, 0, s63
    s_lshl_b32 s43, s63, 17
    s_add_u32 s63, s63, 1
    s_cmp_eq_u32 s63, 10
    s_cselect_b32 s63, 0, s63
    s_lshl_b32 s44, s63, 17
    s_add_u32 s63, s63, 1
    s_cmp_eq_u32 s63, 10
    s_cselect_b32 s63, 0, s63
    s_lshl_b32 s45, s63, 17
    s_add_u32 s63, s63, 1
    s_cmp_eq_u32 s63, 10
    s_cselect_b32 s63, 0, s63
    s_lshl_b32 s46, s63, 17
    s_add_u32 s63, s63, 1
    s_cmp_eq_u32 s63, 10
    s_cselect_b32 s63, 0, s63
    s_lshl_b32 s47, s63, 17
    s_add_u32 s63, s63, 1
    s_cmp_eq_u32 s63, 10
    s_cselect_b32 s63, 0, s63
    s_lshl_b32 s48, s63, 17
    s_add_u32 s63, s63, 1
    s_cmp_eq_u32 s63, 10
    s_cselect_b32 s63, 0, s63
    s_lshl_b32 s49, s63, 17
    s_mov_b32 s50, 1310720
    s_waitcnt lgkmcnt(0)
    s_cmp_eq_u32 s7, 15
    s_cbranch_scc1 L_dma_g
    s_waitcnt vmcnt(0)
    s_barrier
    s_mul_i32 s65, s61, 176128
    s_add_u32 m0, s68, 45056
    s_add_u32 s65, s65, s24
    buffer_load_dwordx4 v26, s[28:31], s65 offen offset:0 lds
    buffer_load_dwordx4 v27, s[28:31], s65 offen offset:1024 lds
    buffer_load_dwordx4 v28, s[28:31], s65 offen offset:2048 lds
    s_add_u32 m0, s68, 48128
    s_add_u32 s65, s65, 44032
    buffer_load_dwordx4 v26, s[28:31], s65 offen offset:0 lds
    buffer_load_dwordx4 v27, s[28:31], s65 offen offset:1024 lds
    buffer_load_dwordx4 v28, s[28:31], s65 offen offset:2048 lds
    s_lshl_b32 s65, s61, 7
    s_add_u32 m0, s67, 28672
    s_add_u32 s65, s65, s25
    buffer_load_dwordx4 v10, s[8:11], s65 offen offset:0 lds
    buffer_load_dwordx4 v11, s[8:11], s65 offen offset:1024 lds
    buffer_load_dwordx4 v12, s[8:11], s65 offen offset:2048 lds
    buffer_load_dwordx4 v13, s[8:11], s65 offen offset:3072 lds
    s_add_u32 m0, s67, 32768
    s_add_u32 s65, s65, 32768
    buffer_load_dwordx4 v10, s[8:11], s65 offen offset:0 lds
    buffer_load_dwordx4 v11, s[8:11], s65 offen offset:1024 lds
    buffer_load_dwordx4 v12, s[8:11], s65 offen offset:2048 lds
    buffer_load_dwordx4 v13, s[8:11], s65 offen offset:3072 lds
    s_add_u32 s61, s61, 1
    s_and_b32 s61, s61, 7
    s_mul_i32 s65, s61, 176128
    s_add_u32 m0, s68, 73728
    s_add_u32 s65, s65, s24
    buffer_load_dwordx4 v26, s[28:31], s65 offen offset:0 lds
    buffer_load_dwordx4 v27, s[28:31], s65 offen offset:1024 lds
    buffer_load_dwordx4 v28, s[28:31], s65 offen offset:2048 lds
    s_add_u32 m0, s68, 76800
    s_add_u32 s65, s65, 44032
    buffer_load_dwordx4 v26, s[28:31], s65 offen offset:0 lds
    buffer_load_dwordx4 v27, s[28:31], s65 offen offset:1024 lds
    buffer_load_dwordx4 v28, s[28:31], s65 offen offset:2048 lds
    s_waitcnt vmcnt(18)
    s_lshl_b32 s65, s61, 7
    s_add_u32 m0, s67, 57344
    s_add_u32 s65, s65, s25
    buffer_load_dwordx4 v10, s[8:11], s65 offen offset:0 lds
    buffer_load_dwordx4 v11, s[8:11], s65 offen offset:1024 lds
    buffer_load_dwordx4 v12, s[8:11], s65 offen offset:2048 lds
    buffer_load_dwordx4 v13, s[8:11], s65 offen offset:3072 lds
    s_add_u32 m0, s67, 61440
    s_add_u32 s65, s65, 32768
    buffer_load_dwordx4 v10, s[8:11], s65 offen offset:0 lds
    buffer_load_dwordx4 v11, s[8:11], s65 offen offset:1024 lds
    buffer_load_dwordx4 v12, s[8:11], s65 offen offset:2048 lds
    buffer_load_dwordx4 v13, s[8:11], s65 offen offset:3072 lds
    s_add_u32 s61, s61, 1
    s_and_b32 s61, s61, 7
    s_waitcnt vmcnt(20)
    s_mul_i32 s65, s61, 176128
    s_add_u32 m0, s68, 102400
    s_add_u32 s65, s65, s24
    buffer_load_dwordx4 v26, s[28:31], s65 offen offset:0 lds
    buffer_load_dwordx4 v27, s[28:31], s65 offen offset:1024 lds
    buffer_load_dwordx4 v28, s[28:31], s65 offen offset:2048 lds
    s_add_u32 m0, s68, 105472
    s_add_u32 s65, s65, 44032
    buffer_load_dwordx4 v26, s[28:31], s65 offen offset:0 lds
    buffer_load_dwordx4 v27, s[28:31], s65 offen offset:1024 lds
    buffer_load_dwordx4 v28, s[28:31], s65 offen offset:2048 lds
    s_waitcnt vmcnt(20)
    s_barrier
    s_waitcnt vmcnt(18)
    s_lshl_b32 s65, s61, 7
    s_add_u32 m0, s67, 86016
    s_add_u32 s65, s65, s25
    buffer_load_dwordx4 v10, s[8:11], s65 offen offset:0 lds
    buffer_load_dwordx4 v11, s[8:11], s65 offen offset:1024 lds
    buffer_load_dwordx4 v12, s[8:11], s65 offen offset:2048 lds
    buffer_load_dwordx4 v13, s[8:11], s65 offen offset:3072 lds
    s_add_u32 m0, s67, 90112
    s_add_u32 s65, s65, 32768
    buffer_load_dwordx4 v10, s[8:11], s65 offen offset:0 lds
    buffer_load_dwordx4 v11, s[8:11], s65 offen offset:1024 lds
    buffer_load_dwordx4 v12, s[8:11], s65 offen offset:2048 lds
    buffer_load_dwordx4 v13, s[8:11], s65 offen offset:3072 lds
    s_add_u32 s61, s61, 1
    s_and_b32 s61, s61, 7
    s_waitcnt vmcnt(20)
    s_mul_i32 s65, s61, 176128
    s_add_u32 m0, s68, 16384
    s_add_u32 s65, s65, s24
    buffer_load_dwordx4 v26, s[28:31], s65 offen offset:0 lds
    buffer_load_dwordx4 v27, s[28:31], s65 offen offset:1024 lds
    buffer_load_dwordx4 v28, s[28:31], s65 offen offset:2048 lds
    s_add_u32 m0, s68, 19456
    s_add_u32 s65, s65, 44032
    buffer_load_dwordx4 v26, s[28:31], s65 offen offset:0 lds
    buffer_load_dwordx4 v27, s[28:31], s65 offen offset:1024 lds
    buffer_load_dwordx4 v28, s[28:31], s65 offen offset:2048 lds
    s_waitcnt vmcnt(20)
    s_barrier
    s_waitcnt vmcnt(18)
    s_lshl_b32 s65, s61, 7
    s_add_u32 m0, s67, 0
    s_add_u32 s65, s65, s25
    buffer_load_dwordx4 v10, s[8:11], s65 offen offset:0 lds
    buffer_load_dwordx4 v11, s[8:11], s65 offen offset:1024 lds
    buffer_load_dwordx4 v12, s[8:11], s65 offen offset:2048 lds
    buffer_load_dwordx4 v13, s[8:11], s65 offen offset:3072 lds
    s_add_u32 m0, s67, 4096
    s_add_u32 s65, s65, 32768
    buffer_load_dwordx4 v10, s[8:11], s65 offen offset:0 lds
    buffer_load_dwordx4 v11, s[8:11], s65 offen offset:1024 lds
    buffer_load_dwordx4 v12, s[8:11], s65 offen offset:2048 lds
    buffer_load_dwordx4 v13, s[8:11], s65 offen offset:3072 lds
    s_add_u32 s61, s61, 1
    s_and_b32 s61, s61, 7
    s_waitcnt vmcnt(20)
    s_mul_i32 s65, s61, 176128
    s_add_u32 m0, s68, 45056
    s_add_u32 s65, s65, s24
    buffer_load_dwordx4 v26, s[28:31], s65 offen offset:0 lds
    buffer_load_dwordx4 v27, s[28:31], s65 offen offset:1024 lds
    buffer_load_dwordx4 v28, s[28:31], s65 offen offset:2048 lds
    s_add_u32 m0, s68, 48128
    s_add_u32 s65, s65, 44032
    buffer_load_dwordx4 v26, s[28:31], s65 offen offset:0 lds
    buffer_load_dwordx4 v27, s[28:31], s65 offen offset:1024 lds
    buffer_load_dwordx4 v28, s[28:31], s65 offen offset:2048 lds
    s_waitcnt vmcnt(20)
    s_barrier
    s_waitcnt vmcnt(18)
    s_lshl_b32 s65, s61, 7
    s_add_u32 m0, s67, 28672
    s_add_u32 s65, s65, s25
    buffer_load_dwordx4 v10, s[8:11], s65 offen offset:0 lds
    buffer_load_dwordx4 v11, s[8:11], s65 offen offset:1024 lds
    buffer_load_dwordx4 v12, s[8:11], s65 offen offset:2048 lds
    buffer_load_dwordx4 v13, s[8:11], s65 offen offset:3072 lds
    s_add_u32 m0, s67, 32768
    s_add_u32 s65, s65, 32768
    buffer_load_dwordx4 v10, s[8:11], s65 offen offset:0 lds
    buffer_load_dwordx4 v11, s[8:11], s65 offen offset:1024 lds
    buffer_load_dwordx4 v12, s[8:11], s65 offen offset:2048 lds
    buffer_load_dwordx4 v13, s[8:11], s65 offen offset:3072 lds
    s_add_u32 s61, s61, 1
    s_and_b32 s61, s61, 7
    s_waitcnt vmcnt(20)
    s_mul_i32 s65, s61, 176128
    s_add_u32 m0, s68, 73728
    s_add_u32 s65, s65, s24
    buffer_load_dwordx4 v26, s[28:31], s65 offen offset:0 lds
    buffer_load_dwordx4 v27, s[28:31], s65 offen offset:1024 lds
    buffer_load_dwordx4 v28, s[28:31], s65 offen offset:2048 lds
    s_add_u32 m0, s68, 76800
    s_add_u32 s65, s65, 44032
    buffer_load_dwordx4 v26, s[28:31], s65 offen offset:0 lds
    buffer_load_dwordx4 v27, s[28:31], s65 offen offset:1024 lds
    buffer_load_dwordx4 v28, s[28:31], s65 offen offset:2048 lds
    s_waitcnt vmcnt(20)
    s_barrier
    s_waitcnt vmcnt(18)
    s_lshl_b32 s65, s61, 7
    s_add_u32 m0, s67, 57344
    s_add_u32 s65, s65, s25
    buffer_load_dwordx4 v10, s[8:11], s65 offen offset:0 lds
    buffer_load_dwordx4 v11, s[8:11], s65 offen offset:1024 lds
    buffer_load_dwordx4 v12, s[8:11], s65 offen offset:2048 lds
    buffer_load_dwordx4 v13, s[8:11], s65 offen offset:3072 lds
    s_add_u32 m0, s67, 61440
    s_add_u32 s65, s65, 32768
    buffer_load_dwordx4 v10, s[8:11], s65 offen offset:0 lds
    buffer_load_dwordx4 v11, s[8:11], s65 offen offset:1024 lds
    buffer_load_dwordx4 v12, s[8:11], s65 offen offset:2048 lds
    buffer_load_dwordx4 v13, s[8:11], s65 offen offset:3072 lds
    s_add_u32 s61, s61, 1
    s_and_b32 s61, s61, 7
    s_waitcnt vmcnt(20)
    s_mul_i32 s65, s61, 176128
    s_add_u32 m0, s68, 102400
    s_add_u32 s65, s65, s24
    buffer_load_dwordx4 v26, s[28:31], s65 offen offset:0 lds
    buffer_load_dwordx4 v27, s[28:31], s65 offen offset:1024 lds
    buffer_load_dwordx4 v28, s[28:31], s65 offen offset:2048 lds
    s_add_u32 m0, s68, 105472
    s_add_u32 s65, s65, 44032
    buffer_load_dwordx4 v26, s[28:31], s65 offen offset:0 lds
    buffer_load_dwordx4 v27, s[28:31], s65 offen offset:1024 lds
    buffer_load_dwordx4 v28, s[28:31], s65 offen offset:2048 lds
    s_waitcnt vmcnt(20)
    s_barrier
    s_waitcnt vmcnt(18)
    s_lshl_b32 s65, s61, 7
    s_add_u32 m0, s67, 86016
    s_add_u32 s65, s65, s25
    buffer_load_dwordx4 v10, s[8:11], s65 offen offset:0 lds
    buffer_load_dwordx4 v11, s[8:11], s65 offen offset:1024 lds
    buffer_load_dwordx4 v12, s[8:11], s65 offen offset:2048 lds
    buffer_load_dwordx4 v13, s[8:11], s65 offen offset:3072 lds
    s_add_u32 m0, s67, 90112
    s_add_u32 s65, s65, 32768
    buffer_load_dwordx4 v10, s[8:11], s65 offen offset:0 lds
    buffer_load_dwordx4 v11, s[8:11], s65 offen offset:1024 lds
    buffer_load_dwordx4 v12, s[8:11], s65 offen offset:2048 lds
    buffer_load_dwordx4 v13, s[8:11], s65 offen offset:3072 lds
    s_add_u32 s61, s61, 1
    s_and_b32 s61, s61, 7
    s_waitcnt vmcnt(22)
    buffer_load_dwordx4 v[32:35], v16, s[36:39], s48 offen offset:0
    buffer_load_dwordx4 v[36:39], v17, s[36:39], s48 offen offset:1024
    buffer_load_dwordx4 v[40:43], v18, s[36:39], s48 offen offset:2048
    buffer_load_dwordx4 v[44:47], v19, s[36:39], s48 offen offset:3072
    s_waitcnt vmcnt(18)
    s_barrier
    buffer_load_dwordx4 v[48:51], v20, s[36:39], s48 offen offset:0
    buffer_load_dwordx4 v[52:55], v21, s[36:39], s48 offen offset:1024
    buffer_load_dwordx4 v[56:59], v22, s[36:39], s48 offen offset:2048
    buffer_load_dwordx4 v[60:63], v23, s[36:39], s48 offen offset:3072
    buffer_load_dwordx4 v[64:67], v16, s[36:39], s49 offen offset:0
    buffer_load_dwordx4 v[68:71], v17, s[36:39], s49 offen offset:1024
    buffer_load_dwordx4 v[72:75], v18, s[36:39], s49 offen offset:2048
    buffer_load_dwordx4 v[76:79], v19, s[36:39], s49 offen offset:3072
    s_waitcnt vmcnt(12)
    s_barrier
    buffer_load_dwordx4 v[80:83], v20, s[36:39], s49 offen offset:0
    buffer_load_dwordx4 v[84:87], v21, s[36:39], s49 offen offset:1024
    buffer_load_dwordx4 v[88:91], v22, s[36:39], s49 offen offset:2048
    buffer_load_dwordx4 v[92:95], v23, s[36:39], s49 offen offset:3072
    s_add_u32 m0, s69, 114688
    s_nop 0
    buffer_load_dwordx4 v16, s[36:39], s40 offen offset:0 lds
    buffer_load_dwordx4 v17, s[36:39], s40 offen offset:1024 lds
    buffer_load_dwordx4 v18, s[36:39], s40 offen offset:2048 lds
    buffer_load_dwordx4 v19, s[36:39], s40 offen offset:3072 lds
    s_barrier
    s_setprio 0
    s_waitcnt vmcnt(16)
    s_add_u32 m0, s69, 122880
    s_nop 0
    buffer_load_dwordx4 v20, s[36:39], s40 offen offset:0 lds
    buffer_load_dwordx4 v21, s[36:39], s40 offen offset:1024 lds
    buffer_load_dwordx4 v22, s[36:39], s40 offen offset:2048 lds
    buffer_load_dwordx4 v23, s[36:39], s40 offen offset:3072 lds
    s_waitcnt vmcnt(16)
    s_add_u32 m0, s69, 98304
    s_nop 0
    buffer_load_dwordx4 v16, s[36:39], s41 offen offset:0 lds
    buffer_load_dwordx4 v17, s[36:39], s41 offen offset:1024 lds
    buffer_load_dwordx4 v18, s[36:39], s41 offen offset:2048 lds
    buffer_load_dwordx4 v19, s[36:39], s41 offen offset:3072 lds
    s_waitcnt vmcnt(16)
    s_add_u32 m0, s69, 106496
    s_nop 0
    buffer_load_dwordx4 v20, s[36:39], s41 offen offset:0 lds
    buffer_load_dwordx4 v21, s[36:39], s41 offen offset:1024 lds
    buffer_load_dwordx4 v22, s[36:39], s41 offen offset:2048 lds
    buffer_load_dwordx4 v23, s[36:39], s41 offen offset:3072 lds
Lw_1:
    ds_read_b32 v3, v9 offset:8
    s_sleep 1
    s_waitcnt lgkmcnt(0)
    v_readfirstlane_b32 s63, v3
    s_nop 0
    s_cmp_lg_u32 s63, 1277952
    s_cbranch_scc1 Lw_1
    s_waitcnt vmcnt(16)
    s_add_u32 m0, s69, 0
    s_nop 0
    buffer_load_dwordx4 v16, s[36:39], s42 offen offset:0 lds
    buffer_load_dwordx4 v17, s[36:39], s42 offen offset:1024 lds
    buffer_load_dwordx4 v18, s[36:39], s42 offen offset:2048 lds
    buffer_load_dwordx4 v19, s[36:39], s42 offen offset:3072 lds
    s_waitcnt vmcnt(16)
    s_add_u32 m0, s69, 8192
    s_nop 0
    buffer_load_dwordx4 v20, s[36:39], s42 offen offset:0 lds
    buffer_load_dwordx4 v21, s[36:39], s42 offen offset:1024 lds
    buffer_load_dwordx4 v22, s[36:39], s42 offen offset:2048 lds
    buffer_load_dwordx4 v23, s[36:39], s42 offen offset:3072 lds
    s_waitcnt vmcnt(16)
    s_add_u32 m0, s69, 16384
    s_nop 0
    buffer_load_dwordx4 v16, s[36:39], s43 offen offset:0 lds
    buffer_load_dwordx4 v17, s[36:39], s43 offen offset:1024 lds
    buffer_load_dwordx4 v18, s[36:39], s43 offen offset:2048 lds
    buffer_load_dwordx4 v19, s[36:39], s43 offen offset:3072 lds
    s_waitcnt vmcnt(16)
    s_add_u32 m0, s69, 24576
    s_nop 0
    buffer_load_dwordx4 v20, s[36:39], s43 offen offset:0 lds
    buffer_load_dwordx4 v21, s[36:39], s43 offen offset:1024 lds
    buffer_load_dwordx4 v22, s[36:39], s43 offen offset:2048 lds
    buffer_load_dwordx4 v23, s[36:39], s43 offen offset:3072 lds
    s_waitcnt vmcnt(16)
    s_add_u32 m0, s69, 32768
    s_nop 0
    buffer_load_dwordx4 v16, s[36:39], s44 offen offset:0 lds
    buffer_load_dwordx4 v17, s[36:39], s44 offen offset:1024 lds
    buffer_load_dwordx4 v18, s[36:39], s44 offen offset:2048 lds
    buffer_load_dwordx4 v19, s[36:39], s44 offen offset:3072 lds
    s_waitcnt vmcnt(16)
    s_add_u32 m0, s69, 40960
    s_nop 0
    buffer_load_dwordx4 v20, s[36:39], s44 offen offset:0 lds
    buffer_load_dwordx4 v21, s[36:39], s44 offen offset:1024 lds
    buffer_load_dwordx4 v22, s[36:39], s44 offen offset:2048 lds
    buffer_load_dwordx4 v23, s[36:39], s44 offen offset:3072 lds
    s_waitcnt vmcnt(16)
    s_add_u32 m0, s69, 49152
    s_nop 0
    buffer_load_dwordx4 v16, s[36:39], s45 offen offset:0 lds
    buffer_load_dwordx4 v17, s[36:39], s45 offen offset:1024 lds
    buffer_load_dwordx4 v18, s[36:39], s45 offen offset:2048 lds
    buffer_load_dwordx4 v19, s[36:39], s45 offen offset:3072 lds
    s_waitcnt vmcnt(16)
    s_add_u32 m0, s69, 57344
    s_nop 0
    buffer_load_dwordx4 v20, s[36:39], s45 offen offset:0 lds
    buffer_load_dwordx4 v21, s[36:39], s45 offen offset:1024 lds
    buffer_load_dwordx4 v22, s[36:39], s45 offen offset:2048 lds
    buffer_load_dwordx4 v23, s[36:39], s45 offen offset:3072 lds
    s_waitcnt vmcnt(16)
    s_add_u32 m0, s69, 65536
    s_nop 0
    buffer_load_dwordx4 v16, s[36:39], s46 offen offset:0 lds
    buffer_load_dwordx4 v17, s[36:39], s46 offen offset:1024 lds
    buffer_load_dwordx4 v18, s[36:39], s46 offen offset:2048 lds
    buffer_load_dwordx4 v19, s[36:39], s46 offen offset:3072 lds
    s_waitcnt vmcnt(16)
    s_add_u32 m0, s69, 73728
    s_nop 0
    buffer_load_dwordx4 v20, s[36:39], s46 offen offset:0 lds
    buffer_load_dwordx4 v21, s[36:39], s46 offen offset:1024 lds
    buffer_load_dwordx4 v22, s[36:39], s46 offen offset:2048 lds
    buffer_load_dwordx4 v23, s[36:39], s46 offen offset:3072 lds
    s_waitcnt vmcnt(16)
    s_add_u32 m0, s69, 81920
    s_nop 0
    buffer_load_dwordx4 v16, s[36:39], s47 offen offset:0 lds
    buffer_load_dwordx4 v17, s[36:39], s47 offen offset:1024 lds
    buffer_load_dwordx4 v18, s[36:39], s47 offen offset:2048 lds
    buffer_load_dwordx4 v19, s[36:39], s47 offen offset:3072 lds
    s_waitcnt vmcnt(16)
    s_add_u32 m0, s69, 90112
    s_nop 0
    buffer_load_dwordx4 v20, s[36:39], s47 offen offset:0 lds
    buffer_load_dwordx4 v21, s[36:39], s47 offen offset:1024 lds
    buffer_load_dwordx4 v22, s[36:39], s47 offen offset:2048 lds
    buffer_load_dwordx4 v23, s[36:39], s47 offen offset:3072 lds
    s_waitcnt vmcnt(16)
    buffer_load_dwordx4 v[96:99], v16, s[36:39], s50 offen offset:0
    buffer_load_dwordx4 v[100:103], v17, s[36:39], s50 offen offset:1024
    buffer_load_dwordx4 v[104:107], v18, s[36:39], s50 offen offset:2048
    buffer_load_dwordx4 v[108:111], v19, s[36:39], s50 offen offset:3072
    s_waitcnt vmcnt(16)
    buffer_load_dwordx4 v[112:115], v20, s[36:39], s50 offen offset:0
    buffer_load_dwordx4 v[116:119], v21, s[36:39], s50 offen offset:1024
    buffer_load_dwordx4 v[120:123], v22, s[36:39], s50 offen offset:2048
    buffer_load_dwordx4 v[124:127], v23, s[36:39], s50 offen offset:3072
    s_setprio 0
    s_waitcnt vmcnt(8)
L_dma_end:
    s_mov_b64 exec, 1
    ds_add_u32 v9, v9 offset:16
    s_mov_b64 exec, -1
Lw_2:
    ds_read_b32 v3, v9 offset:28
    s_sleep 1
    s_waitcnt lgkmcnt(0)
    v_readfirstlane_b32 s63, v3
    s_nop 0
    s_cmp_lg_u32 s63, 638976
    s_cbranch_scc1 Lw_2
    s_waitcnt vmcnt(0)
    ds_write_b128 v30, v[32:35] offset:16384
    ds_write_b128 v30, v[36:39] offset:17408
    ds_write_b128 v30, v[40:43] offset:18432
    ds_write_b128 v30, v[44:47] offset:19456
    ds_write_b128 v30, v[48:51] offset:24576
    ds_write_b128 v30, v[52:55] offset:25600
    ds_write_b128 v30, v[56:59] offset:26624
    ds_write_b128 v30, v[60:63] offset:27648
    ds_write_b128 v30, v[96:99] offset:32768
    ds_write_b128 v30, v[100:103] offset:33792
    ds_write_b128 v30, v[104:107] offset:34816
    ds_write_b128 v30, v[108:111] offset:35840
    s_cmp_eq_u32 s3, 1
    s_cbranch_scc1 Ld1_3
    ds_write_b128 v30, v[112:115] offset:40960
    ds_write_b128 v30, v[116:119] offset:41984
    ds_write_b128 v30, v[120:123] offset:43008
    ds_write_b128 v30, v[124:127] offset:44032
Ld1_3:
    s_barrier
    ds_write_b128 v30, v[64:67] offset:0
    ds_write_b128 v30, v[68:71] offset:1024
    ds_write_b128 v30, v[72:75] offset:2048
    ds_write_b128 v30, v[76:79] offset:3072
    ds_write_b128 v30, v[80:83] offset:8192
    ds_write_b128 v30, v[84:87] offset:9216
    ds_write_b128 v30, v[88:91] offset:10240
    ds_write_b128 v30, v[92:95] offset:11264
    s_waitcnt lgkmcnt(0)
    s_barrier
    s_endpgm
L_dma_special:
    v_bfrev_b32 v7, 2
    v_lshrrev_b32 v4, 2, v1
    v_add_u32 v5, 0, v4
    v_mul_u32_u24 v6, 11, v5
    v_lshrrev_b32 v6, 5, v6
    v_mul_u32_u24 v6, 3, v6
    v_cmp_ne_u32 vcc, v5, v6
    s_nop 1
    v_cndmask_b32 v26, v26, v7, vcc
    v_add_u32 v5, 1, v4
    v_mul_u32_u24 v6, 11, v5
    v_lshrrev_b32 v6, 5, v6
    v_mul_u32_u24 v6, 3, v6
    v_cmp_ne_u32 vcc, v5, v6
    s_nop 1
    v_cndmask_b32 v27, v27, v7, vcc
    v_add_u32 v5, 2, v4
    v_mul_u32_u24 v6, 11, v5
    v_lshrrev_b32 v6, 5, v6
    v_mul_u32_u24 v6, 3, v6
    v_cmp_ne_u32 vcc, v5, v6
    s_nop 1
    v_cndmask_b32 v28, v28, v7, vcc
    s_cmp_eq_u32 s7, 14
    s_cbranch_scc1 L_dma_go
    s_brev_b32 s24, 2
    s_branch L_dma_go
L_dma_g:
    s_lshl1_add_u32 s63, s6, s3
    s_mul_i32 s63, s63, 44032
    s_mov_b32 s56, 11
L_dma_gl:
    buffer_load_dwordx4 v[32:35], v8, s[36:39], s63 offen offset:0
    buffer_load_dwordx4 v[36:39], v8, s[36:39], s63 offen offset:1024
    buffer_load_dwordx4 v[40:43], v8, s[36:39], s63 offen offset:2048
    buffer_load_dwordx4 v[44:47], v8, s[36:39], s63 offen offset:3072
    s_waitcnt vmcnt(12)
    s_add_u32 s63, s63, 4096
    s_sub_u32 s56, s56, 1
    s_cmp_lg_u32 s56, 6
    s_cbranch_scc1 Lg0_4
    s_barrier
Lg0_4:
    s_cmp_lg_u32 s56, 0
    s_cbranch_scc1 L_dma_gl
    s_waitcnt vmcnt(8)
    s_add_u32 m0, s69, 98304
    s_nop 0
    buffer_load_dwordx4 v16, s[36:39], s41 offen offset:0 lds
    buffer_load_dwordx4 v17, s[36:39], s41 offen offset:1024 lds
    buffer_load_dwordx4 v18, s[36:39], s41 offen offset:2048 lds
    buffer_load_dwordx4 v19, s[36:39], s41 offen offset:3072 lds
    s_waitcnt vmcnt(8)
    s_add_u32 m0, s69, 106496
    s_nop 0
    buffer_load_dwordx4 v20, s[36:39], s41 offen offset:0 lds
    buffer_load_dwordx4 v21, s[36:39], s41 offen offset:1024 lds
    buffer_load_dwordx4 v22, s[36:39], s41 offen offset:2048 lds
    buffer_load_dwordx4 v23, s[36:39], s41 offen offset:3072 lds
    s_waitcnt vmcnt(8)
    s_add_u32 m0, s69, 0
    s_nop 0
    buffer_load_dwordx4 v16, s[36:39], s42 offen offset:0 lds
    buffer_load_dwordx4 v17, s[36:39], s42 offen offset:1024 lds
    buffer_load_dwordx4 v18, s[36:39], s42 offen offset:2048 lds
    buffer_load_dwordx4 v19, s[36:39], s42 offen offset:3072 lds
    s_waitcnt vmcnt(8)
    s_add_u32 m0, s69, 8192
    s_nop 0
    buffer_load_dwordx4 v20, s[36:39], s42 offen offset:0 lds
    buffer_load_dwordx4 v21, s[36:39], s42 offen offset:1024 lds
    buffer_load_dwordx4 v22, s[36:39], s42 offen offset:2048 lds
    buffer_load_dwordx4 v23, s[36:39], s42 offen offset:3072 lds
    s_waitcnt vmcnt(8)
    s_add_u32 m0, s69, 16384
    s_nop 0
    buffer_load_dwordx4 v16, s[36:39], s43 offen offset:0 lds
    buffer_load_dwordx4 v17, s[36:39], s43 offen offset:1024 lds
    buffer_load_dwordx4 v18, s[36:39], s43 offen offset:2048 lds
    buffer_load_dwordx4 v19, s[36:39], s43 offen offset:3072 lds
    s_waitcnt vmcnt(8)
    s_add_u32 m0, s69, 24576
    s_nop 0
    buffer_load_dwordx4 v20, s[36:39], s43 offen offset:0 lds
    buffer_load_dwordx4 v21, s[36:39], s43 offen offset:1024 lds
    buffer_load_dwordx4 v22, s[36:39], s43 offen offset:2048 lds
    buffer_load_dwordx4 v23, s[36:39], s43 offen offset:3072 lds
    s_waitcnt vmcnt(8)
    s_add_u32 m0, s69, 32768
    s_nop 0
    buffer_load_dwordx4 v16, s[36:39], s44 offen offset:0 lds
    buffer_load_dwordx4 v17, s[36:39], s44 offen offset:1024 lds
    buffer_load_dwordx4 v18, s[36:39], s44 offen offset:2048 lds
    buffer_load_dwordx4 v19, s[36:39], s44 offen offset:3072 lds
    s_waitcnt vmcnt(8)
    s_add_u32 m0, s69, 40960
    s_nop 0
    buffer_load_dwordx4 v20, s[36:39], s44 offen offset:0 lds
    buffer_load_dwordx4 v21, s[36:39], s44 offen offset:1024 lds
    buffer_load_dwordx4 v22, s[36:39], s44 offen offset:2048 lds
    buffer_load_dwordx4 v23, s[36:39], s44 offen offset:3072 lds
    s_waitcnt vmcnt(8)
    s_add_u32 m0, s69, 49152
    s_nop 0
    buffer_load_dwordx4 v16, s[36:39], s45 offen offset:0 lds
    buffer_load_dwordx4 v17, s[36:39], s45 offen offset:1024 lds
    buffer_load_dwordx4 v18, s[36:39], s45 offen offset:2048 lds
    buffer_load_dwordx4 v19, s[36:39], s45 offen offset:3072 lds
    s_waitcnt vmcnt(8)
    s_add_u32 m0, s69, 57344
    s_nop 0
    buffer_load_dwordx4 v20, s[36:39], s45 offen offset:0 lds
    buffer_load_dwordx4 v21, s[36:39], s45 offen offset:1024 lds
    buffer_load_dwordx4 v22, s[36:39], s45 offen offset:2048 lds
    buffer_load_dwordx4 v23, s[36:39], s45 offen offset:3072 lds
    s_waitcnt vmcnt(8)
    s_add_u32 m0, s69, 65536
    s_nop 0
    buffer_load_dwordx4 v16, s[36:39], s46 offen offset:0 lds
    buffer_load_dwordx4 v17, s[36:39], s46 offen offset:1024 lds
    buffer_load_dwordx4 v18, s[36:39], s46 offen offset:2048 lds
    buffer_load_dwordx4 v19, s[36:39], s46 offen offset:3072 lds
    s_waitcnt vmcnt(8)
    s_add_u32 m0, s69, 73728
    s_nop 0
    buffer_load_dwordx4 v20, s[36:39], s46 offen offset:0 lds
    buffer_load_dwordx4 v21, s[36:39], s46 offen offset:1024 lds
    buffer_load_dwordx4 v22, s[36:39], s46 offen offset:2048 lds
    buffer_load_dwordx4 v23, s[36:39], s46 offen offset:3072 lds
    s_waitcnt vmcnt(8)
    s_add_u32 m0, s69, 81920
    s_nop 0
    buffer_load_dwordx4 v16, s[36:39], s47 offen offset:0 lds
    buffer_load_dwordx4 v17, s[36:39], s47 offen offset:1024 lds
    buffer_load_dwordx4 v18, s[36:39], s47 offen offset:2048 lds
    buffer_load_dwordx4 v19, s[36:39], s47 offen offset:3072 lds
    s_waitcnt vmcnt(8)
    s_add_u32 m0, s69, 90112
    s_nop 0
    buffer_load_dwordx4 v20, s[36:39], s47 offen offset:0 lds
    buffer_load_dwordx4 v21, s[36:39], s47 offen offset:1024 lds
    buffer_load_dwordx4 v22, s[36:39], s47 offen offset:2048 lds
    buffer_load_dwordx4 v23, s[36:39], s47 offen offset:3072 lds
    s_waitcnt vmcnt(8)
    buffer_load_dwordx4 v[32:35], v16, s[36:39], s48 offen offset:0
    buffer_load_dwordx4 v[36:39], v17, s[36:39], s48 offen offset:1024
    buffer_load_dwordx4 v[40:43], v18, s[36:39], s48 offen offset:2048
    buffer_load_dwordx4 v[44:47], v19, s[36:39], s48 offen offset:3072
    s_waitcnt vmcnt(8)
    buffer_load_dwordx4 v[48:51], v20, s[36:39], s48 offen offset:0
    buffer_load_dwordx4 v[52:55], v21, s[36:39], s48 offen offset:1024
    buffer_load_dwordx4 v[56:59], v22, s[36:39], s48 offen offset:2048
    buffer_load_dwordx4 v[60:63], v23, s[36:39], s48 offen offset:3072
    s_waitcnt vmcnt(8)
    buffer_load_dwordx4 v[64:67], v16, s[36:39], s49 offen offset:0
    buffer_load_dwordx4 v[68:71], v17, s[36:39], s49 offen offset:1024
    buffer_load_dwordx4 v[72:75], v18, s[36:39], s49 offen offset:2048
    buffer_load_dwordx4 v[76:79], v19, s[36:39], s49 offen offset:3072
    s_waitcnt vmcnt(8)
    buffer_load_dwordx4 v[80:83], v20, s[36:39], s49 offen offset:0
    buffer_load_dwordx4 v[84:87], v21, s[36:39], s49 offen offset:1024
    buffer_load_dwordx4 v[88:91], v22, s[36:39], s49 offen offset:2048
    buffer_load_dwordx4 v[92:95], v23, s[36:39], s49 offen offset:3072
    s_waitcnt vmcnt(8)
    buffer_load_dwordx4 v[96:99], v16, s[36:39], s50 offen offset:0
    buffer_load_dwordx4 v[100:103], v17, s[36:39], s50 offen offset:1024
    buffer_load_dwordx4 v[104:107], v18, s[36:39], s50 offen offset:2048
    buffer_load_dwordx4 v[108:111], v19, s[36:39], s50 offen offset:3072
    s_waitcnt vmcnt(8)
    buffer_load_dwordx4 v[112:115], v20, s[36:39], s50 offen offset:0
    buffer_load_dwordx4 v[116:119], v21, s[36:39], s50 offen offset:1024
    buffer_load_dwordx4 v[120:123], v22, s[36:39], s50 offen offset:2048
    buffer_load_dwordx4 v[124:127], v23, s[36:39], s50 offen offset:3072
Lw_5:
    ds_read_b32 v3, v9 offset:4
    s_sleep 1
    s_waitcnt lgkmcnt(0)
    v_readfirstlane_b32 s63, v3
    s_nop 0
    s_cmp_lg_u32 s63, 958464
    s_cbranch_scc1 Lw_5
    s_waitcnt vmcnt(8)
    s_add_u32 m0, s69, 114688
    s_nop 0
    buffer_load_dwordx4 v16, s[36:39], s40 offen offset:0 lds
    buffer_load_dwordx4 v17, s[36:39], s40 offen offset:1024 lds
    buffer_load_dwordx4 v18, s[36:39], s40 offen offset:2048 lds
    buffer_load_dwordx4 v19, s[36:39], s40 offen offset:3072 lds
    s_waitcnt vmcnt(8)
    s_add_u32 m0, s69, 122880
    s_nop 0
    buffer_load_dwordx4 v20, s[36:39], s40 offen offset:0 lds
    buffer_load_dwordx4 v21, s[36:39], s40 offen offset:1024 lds
    buffer_load_dwordx4 v22, s[36:39], s40 offen offset:2048 lds
    buffer_load_dwordx4 v23, s[36:39], s40 offen offset:3072 lds
    s_waitcnt vmcnt(0)
    s_branch L_dma_end
L_service:
    s_setprio 3
    s_lshl_b32 s14, 1, 21
    s_mov_b32 s15, 0x20000
    s_mov_b64 s[18:19], s[14:15]
    s_sub_u32 s60, s3, 2
    v_and_b32 v5, 2, v2
    v_xor_b32 v5, v5, v3
    v_lshlrev_b32 v5, 4, v5
    v_lshl_add_u32 v5, v2, 10, v5
    s_lshl1_add_u32 s63, s5, s60
    s_lshl_b32 s63, s63, 8
    s_add_u32 s63, s63, s4
    s_lshl_b32 s63, s63, 7
    v_add_u32 v5, s63, v5
    v_xor_b32 v116, 64, v5
    v_add_u32 v117, 7168, v5
    v_add_u32 v118, 14336, v116
    v_add_u32 v119, 21504, v5
    v_subrev_u32 v120, 0x2000, v5
    s_mul_i32 s67, s60, 9216
    v_and_b32 v6, 15, v1
    v_lshlrev_b32 v7, 3, v6
    s_lshl_b32 s65, s4, 9
    s_movk_i32 s22, 4096
    s_mov_b32 s23, s15
    s_add_u32 m0, s67, 115712
    s_waitcnt lgkmcnt(0)
    s_mov_b64 s[12:13], s[88:89]
    s_mov_b64 s[16:17], s[90:91]
    s_mov_b64 s[20:21], s[92:93]
    s_load_dwordx2 s[44:45], s[0:1], 88
    s_load_dwordx2 s[52:53], s[0:1], 112
    buffer_load_dwordx2 v[40:41], v7, s[20:23], s65 offen offset:0
    buffer_load_dwordx2 v[42:43], v7, s[20:23], s65 offen offset:128
    buffer_load_dwordx2 v[44:45], v7, s[20:23], s65 offen offset:256
    buffer_load_dwordx2 v[46:47], v7, s[20:23], s65 offen offset:384
    s_mov_b32 s46, 1024
    s_mov_b32 s47, 0x20000
    s_mov_b32 s54, 268435456
    s_mov_b32 s55, 0x20000
    s_mov_b32 s10, 2097152
    s_mov_b32 s11, 0x20000
    s_lshr_b32 s63, s5, 4
    s_lshl1_add_u32 s6, s4, s63
    s_and_b32 s7, s5, 15
    s_lshl_b32 s64, s7, 2
    s_mov_b32 s100, 0x87654210
    s_mov_b32 s101, 0xb3fedca9
    s_lshr_b64 s[100:101], s[100:101], s64
    s_and_b32 s56, s100, 7
    s_bfe_u32 s63, s100, 0x10003
    s_lshl1_add_u32 s63, s6, s63
    s_lshl_b32 s57, s63, 6
    v_lshlrev_b32 v8, 4, v1
    s_lshl_b32 s62, s4, 5
    s_add_u32 s62, s62, s5
    s_lshl1_add_u32 s28, s62, s60
    s_lshl_b32 s28, s28, 12
    s_lshl_b32 s63, s4, 8
    s_lshl_b32 s64, s6, 7
    s_add_u32 s64, s64, 2048
    s_cmp_eq_u32 s60, 0
    s_cselect_b32 s63, s63, s64
    s_add_u32 s63, s63, 8192
    v_lshlrev_b32 v12, 2, v1
    s_waitcnt lgkmcnt(0)
    s_load_dword s58, s[52:53], 4096
    s_load_dword s96, s[52:53], 131072
    buffer_load_dwordx4 v[112:115], v8, s[44:47], 0 offen
    buffer_load_dword v11, v12, s[52:55], s63 offen sc1
    s_lshl_b32 s63, s6, 12
    s_lshl1_add_u32 s64, s7, s60
    s_lshl_b32 s64, s64, 7
    s_add_u32 s63, s63, s64
    s_add_u32 s63, s63, 65536
    buffer_load_dword v11, off, s[52:55], s63 sc1
    buffer_load_dwordx4 v116, s[12:15], 0 offen offset:0 lds
    buffer_load_dwordx4 v117, s[12:15], 0 offen offset:1024 lds
    buffer_load_dwordx4 v118, s[12:15], 0 offen offset:2048 lds
    buffer_load_dwordx4 v119, s[12:15], 0 offen offset:3072 lds
    s_add_u32 m0, s67, 119808
    s_nop 0
    buffer_load_dwordx4 v116, s[16:19], 0 offen offset:0 lds
    buffer_load_dwordx4 v117, s[16:19], 0 offen offset:1024 lds
    buffer_load_dwordx4 v118, s[16:19], 0 offen offset:2048 lds
    buffer_load_dwordx4 v119, s[16:19], 0 offen offset:3072 lds
    s_add_u32 m0, s67, 114688
    s_nop 0
    buffer_load_dwordx4 v120, s[12:15], 0 offen lds
    buffer_load_dwordx4 v[16:19], v8, s[8:11], s28 offen offset:0
    buffer_load_dwordx4 v[20:23], v8, s[8:11], s28 offen offset:1024
    buffer_load_dwordx4 v[24:27], v8, s[8:11], s28 offen offset:2048
    buffer_load_dwordx4 v[28:31], v8, s[8:11], s28 offen offset:3072
    v_mov_b32 v124, 0
    v_mov_b32 v125, 0
    v_mov_b32 v126, 0
    v_mov_b32 v127, 0
    s_mul_i32 s63, s60, 4352
    s_add_u32 s63, s63, 147456
    v_and_b32 v2, 0xf0, v8
    v_add_u32 v2, s63, v2
    v_mov_b32 v14, 159744
    ds_write_b128 v2, v[124:127]
    ds_write_b128 v14, v[124:127]
    ds_write_b128 v14, v[124:127] offset:16
    ds_write_b128 v14, v[124:127] offset:32
    v_lshrrev_b32 v2, 4, v1
    v_bfe_u32 v3, v1, 2, 2
    v_lshl_add_u32 v4, v2, 3, v3
    v_lshlrev_b32 v4, 7, v4
    v_and_b32 v5, 3, v1
    v_lshl_add_u32 v4, v5, 3, v4
    v_lshrrev_b32 v3, 1, v3
    v_and_b32 v5, 1, v2
    v_lshl_or_b32 v3, v5, 1, v3
    v_lshl_add_u32 v13, v3, 5, v4
    s_add_u32 s63, s67, 115200
    v_add_u32 v13, s63, v13
    v_lshrrev_b32 v3, 1, v6
    v_lshlrev_b32 v3, 13, v3
    v_and_b32 v4, 1, v1
    v_lshl_add_u32 v3, v4, 4, v3
    v_lshl_add_u32 v15, v2, 5, v3
    v_mul_u32_u24 v37, 4352, v4
    v_lshrrev_b32 v38, 1, v1
    v_lshl_add_u32 v37, v38, 4, v37
    s_lshl_b32 s64, s60, 11
    s_add_u32 s64, s64, 147712
    v_add_u32 v37, s64, v37
    s_lshl_b32 s29, s4, 18
    s_lshl_b32 s63, s5, 8
    s_add_u32 s29, s29, s63
    s_lshl_b32 s63, s60, 7
    s_add_u32 s29, s29, s63
    s_add_u32 s29, s29, 6291456
    s_lshl_b32 s66, s4, 8
    s_lshl_b32 s63, s5, 3
    s_lshl2_add_u32 s63, s60, s63
    s_add_u32 s68, s63, s66
    s_waitcnt lgkmcnt(0)
    s_add_u32 s58, s58, s96
    s_add_u32 s58, s58, 2654435761
    s_add_u32 s96, s96, 1
    v_mov_b32 v39, s96
    v_mov_b32 v10, s58
    s_mov_b32 s30, s58
    s_mov_b32 s31, s58
    s_barrier
    s_waitcnt vmcnt(4)
    v_mov_b32 v2, v13
    v_xor_b32 v3, 64, v2
    ds_read_b64_tr_b16 v[48:49], v2
    ds_read_b64_tr_b16 v[50:51], v3 offset:512
    ds_read_b64_tr_b16 v[52:53], v3 offset:1024
    ds_read_b64_tr_b16 v[54:55], v3 offset:4608
    ds_read_b64_tr_b16 v[56:57], v3 offset:5120
    v_xor_b32 v2, 32, v13
    v_xor_b32 v3, 64, v2
    ds_read_b64_tr_b16 v[58:59], v2
    ds_read_b64_tr_b16 v[60:61], v3 offset:512
    ds_read_b64_tr_b16 v[62:63], v3 offset:1024
    ds_read_b64_tr_b16 v[64:65], v3 offset:4608
    ds_read_b64_tr_b16 v[66:67], v3 offset:5120
    v_xor_b32 v2, 64, v13
    v_xor_b32 v3, 64, v2
    ds_read_b64_tr_b16 v[68:69], v2
    ds_read_b64_tr_b16 v[70:71], v3 offset:512
    ds_read_b64_tr_b16 v[72:73], v3 offset:1024
    ds_read_b64_tr_b16 v[74:75], v3 offset:4608
    ds_read_b64_tr_b16 v[76:77], v3 offset:5120
    v_xor_b32 v2, 96, v13
    v_xor_b32 v3, 64, v2
    ds_read_b64_tr_b16 v[78:79], v2
    ds_read_b64_tr_b16 v[80:81], v3 offset:512
    ds_read_b64_tr_b16 v[82:83], v3 offset:1024
    ds_read_b64_tr_b16 v[84:85], v3 offset:4608
    ds_read_b64_tr_b16 v[86:87], v3 offset:5120
    v_mov_b32 v4, 0xffff
    v_alignbit_b32 v88, v40, v40, 16
    v_alignbit_b32 v89, v41, v41, 16
    v_and_b32 v90, 0xffff, v40
    v_bfi_b32 v91, v4, v41, v40
    v_and_b32 v92, 0xffff0000, v41
    s_waitcnt lgkmcnt(15)
    v_dot2_f32_bf16 v96, v48, v92, 0
    v_dot2_f32_bf16 v97, v49, v89, 0
    v_dot2_f32_bf16 v98, v49, v92, 0
    v_dot2_f32_bf16 v99, v50, v89, 0
    v_dot2_f32_bf16 v100, v50, v92, 0
    v_dot2_f32_bf16 v101, v51, v89, 0
    v_dot2_f32_bf16 v102, v51, v92, 0
    v_dot2_f32_bf16 v103, v52, v89, 0
    v_dot2_f32_bf16 v96, v49, v91, v96
    v_dot2_f32_bf16 v97, v50, v88, v97
    v_dot2_f32_bf16 v98, v50, v91, v98
    v_dot2_f32_bf16 v99, v51, v88, v99
    v_dot2_f32_bf16 v100, v51, v91, v100
    v_dot2_f32_bf16 v101, v52, v88, v101
    v_dot2_f32_bf16 v102, v52, v91, v102
    v_dot2_f32_bf16 v103, v53, v88, v103
    v_dot2_f32_bf16 v96, v50, v90, v96
    v_dot2_f32_bf16 v98, v51, v90, v98
    v_dot2_f32_bf16 v100, v52, v90, v100
    v_dot2_f32_bf16 v102, v53, v90, v102
    v_lshlrev_b32 v104, 16, v54
    v_and_b32 v105, 0xffff0000, v54
    v_lshlrev_b32 v106, 16, v55
    v_and_b32 v107, 0xffff0000, v55
    v_lshlrev_b32 v108, 16, v56
    v_and_b32 v109, 0xffff0000, v56
    v_lshlrev_b32 v110, 16, v57
    v_and_b32 v111, 0xffff0000, v57
    v_pk_mul_f32 v[96:97], v[96:97], v[104:105]
    v_pk_mul_f32 v[98:99], v[98:99], v[106:107]
    v_pk_mul_f32 v[100:101], v[100:101], v[108:109]
    v_pk_mul_f32 v[102:103], v[102:103], v[110:111]
    v_cvt_pk_bf16_f32 v54, v103, v102
    v_cvt_pk_bf16_f32 v55, v101, v100
    v_cvt_pk_bf16_f32 v56, v99, v98
    v_cvt_pk_bf16_f32 v57, v97, v96
    buffer_store_dwordx4 v[54:57], v15, s[52:55], s29 offen sc1
    s_add_u32 s29, s29, 65536
    v_alignbit_b32 v88, v42, v42, 16
    v_alignbit_b32 v89, v43, v43, 16
    v_and_b32 v90, 0xffff, v42
    v_bfi_b32 v91, v4, v43, v42
    v_and_b32 v92, 0xffff0000, v43
    s_waitcnt lgkmcnt(10)
    v_dot2_f32_bf16 v96, v58, v92, 0
    v_dot2_f32_bf16 v97, v59, v89, 0
    v_dot2_f32_bf16 v98, v59, v92, 0
    v_dot2_f32_bf16 v99, v60, v89, 0
    v_dot2_f32_bf16 v100, v60, v92, 0
    v_dot2_f32_bf16 v101, v61, v89, 0
    v_dot2_f32_bf16 v102, v61, v92, 0
    v_dot2_f32_bf16 v103, v62, v89, 0
    v_dot2_f32_bf16 v96, v59, v91, v96
    v_dot2_f32_bf16 v97, v60, v88, v97
    v_dot2_f32_bf16 v98, v60, v91, v98
    v_dot2_f32_bf16 v99, v61, v88, v99
    v_dot2_f32_bf16 v100, v61, v91, v100
    v_dot2_f32_bf16 v101, v62, v88, v101
    v_dot2_f32_bf16 v102, v62, v91, v102
    v_dot2_f32_bf16 v103, v63, v88, v103
    v_dot2_f32_bf16 v96, v60, v90, v96
    v_dot2_f32_bf16 v98, v61, v90, v98
    v_dot2_f32_bf16 v100, v62, v90, v100
    v_dot2_f32_bf16 v102, v63, v90, v102
    v_lshlrev_b32 v104, 16, v64
    v_and_b32 v105, 0xffff0000, v64
    v_lshlrev_b32 v106, 16, v65
    v_and_b32 v107, 0xffff0000, v65
    v_lshlrev_b32 v108, 16, v66
    v_and_b32 v109, 0xffff0000, v66
    v_lshlrev_b32 v110, 16, v67
    v_and_b32 v111, 0xffff0000, v67
    v_pk_mul_f32 v[96:97], v[96:97], v[104:105]
    v_pk_mul_f32 v[98:99], v[98:99], v[106:107]
    v_pk_mul_f32 v[100:101], v[100:101], v[108:109]
    v_pk_mul_f32 v[102:103], v[102:103], v[110:111]
    v_cvt_pk_bf16_f32 v64, v103, v102
    v_cvt_pk_bf16_f32 v65, v101, v100
    v_cvt_pk_bf16_f32 v66, v99, v98
    v_cvt_pk_bf16_f32 v67, v97, v96
    buffer_store_dwordx4 v[64:67], v15, s[52:55], s29 offen sc1
    s_add_u32 s29, s29, 65536
    v_alignbit_b32 v88, v44, v44, 16
    v_alignbit_b32 v89, v45, v45, 16
    v_and_b32 v90, 0xffff, v44
    v_bfi_b32 v91, v4, v45, v44
    v_and_b32 v92, 0xffff0000, v45
    s_waitcnt lgkmcnt(5)
    v_dot2_f32_bf16 v96, v68, v92, 0
    v_dot2_f32_bf16 v97, v69, v89, 0
    v_dot2_f32_bf16 v98, v69, v92, 0
    v_dot2_f32_bf16 v99, v70, v89, 0
    v_dot2_f32_bf16 v100, v70, v92, 0
    v_dot2_f32_bf16 v101, v71, v89, 0
    v_dot2_f32_bf16 v102, v71, v92, 0
    v_dot2_f32_bf16 v103, v72, v89, 0
    v_dot2_f32_bf16 v96, v69, v91, v96
    v_dot2_f32_bf16 v97, v70, v88, v97
    v_dot2_f32_bf16 v98, v70, v91, v98
    v_dot2_f32_bf16 v99, v71, v88, v99
    v_dot2_f32_bf16 v100, v71, v91, v100
    v_dot2_f32_bf16 v101, v72, v88, v101
    v_dot2_f32_bf16 v102, v72, v91, v102
    v_dot2_f32_bf16 v103, v73, v88, v103
    v_dot2_f32_bf16 v96, v70, v90, v96
    v_dot2_f32_bf16 v98, v71, v90, v98
    v_dot2_f32_bf16 v100, v72, v90, v100
    v_dot2_f32_bf16 v102, v73, v90, v102
    v_lshlrev_b32 v104, 16, v74
    v_and_b32 v105, 0xffff0000, v74
    v_lshlrev_b32 v106, 16, v75
    v_and_b32 v107, 0xffff0000, v75
    v_lshlrev_b32 v108, 16, v76
    v_and_b32 v109, 0xffff0000, v76
    v_lshlrev_b32 v110, 16, v77
    v_and_b32 v111, 0xffff0000, v77
    v_pk_mul_f32 v[96:97], v[96:97], v[104:105]
    v_pk_mul_f32 v[98:99], v[98:99], v[106:107]
    v_pk_mul_f32 v[100:101], v[100:101], v[108:109]
    v_pk_mul_f32 v[102:103], v[102:103], v[110:111]
    v_cvt_pk_bf16_f32 v74, v103, v102
    v_cvt_pk_bf16_f32 v75, v101, v100
    v_cvt_pk_bf16_f32 v76, v99, v98
    v_cvt_pk_bf16_f32 v77, v97, v96
    buffer_store_dwordx4 v[74:77], v15, s[52:55], s29 offen sc1
    s_add_u32 s29, s29, 65536
    s_cmp_eq_u32 s7, 15
    s_cbranch_scc1 Lcb_6
    s_barrier
Lcb_6:
    v_alignbit_b32 v88, v46, v46, 16
    v_alignbit_b32 v89, v47, v47, 16
    v_and_b32 v90, 0xffff, v46
    v_bfi_b32 v91, v4, v47, v46
    v_and_b32 v92, 0xffff0000, v47
    s_waitcnt lgkmcnt(0)
    v_dot2_f32_bf16 v96, v78, v92, 0
    v_dot2_f32_bf16 v97, v79, v89, 0
    v_dot2_f32_bf16 v98, v79, v92, 0
    v_dot2_f32_bf16 v99, v80, v89, 0
    v_dot2_f32_bf16 v100, v80, v92, 0
    v_dot2_f32_bf16 v101, v81, v89, 0
    v_dot2_f32_bf16 v102, v81, v92, 0
    v_dot2_f32_bf16 v103, v82, v89, 0
    v_dot2_f32_bf16 v96, v79, v91, v96
    v_dot2_f32_bf16 v97, v80, v88, v97
    v_dot2_f32_bf16 v98, v80, v91, v98
    v_dot2_f32_bf16 v99, v81, v88, v99
    v_dot2_f32_bf16 v100, v81, v91, v100
    v_dot2_f32_bf16 v101, v82, v88, v101
    v_dot2_f32_bf16 v102, v82, v91, v102
    v_dot2_f32_bf16 v103, v83, v88, v103
    v_dot2_f32_bf16 v96, v80, v90, v96
    v_dot2_f32_bf16 v98, v81, v90, v98
    v_dot2_f32_bf16 v100, v82, v90, v100
    v_dot2_f32_bf16 v102, v83, v90, v102
    v_lshlrev_b32 v104, 16, v84
    v_and_b32 v105, 0xffff0000, v84
    v_lshlrev_b32 v106, 16, v85
    v_and_b32 v107, 0xffff0000, v85
    v_lshlrev_b32 v108, 16, v86
    v_and_b32 v109, 0xffff0000, v86
    v_lshlrev_b32 v110, 16, v87
    v_and_b32 v111, 0xffff0000, v87
    v_pk_mul_f32 v[96:97], v[96:97], v[104:105]
    v_pk_mul_f32 v[98:99], v[98:99], v[106:107]
    v_pk_mul_f32 v[100:101], v[100:101], v[108:109]
    v_pk_mul_f32 v[102:103], v[102:103], v[110:111]
    v_cvt_pk_bf16_f32 v84, v103, v102
    v_cvt_pk_bf16_f32 v85, v101, v100
    v_cvt_pk_bf16_f32 v86, v99, v98
    v_cvt_pk_bf16_f32 v87, v97, v96
    buffer_store_dwordx4 v[84:87], v15, s[52:55], s29 offen sc1
    s_lshr_b32 s28, s28, 7
    s_add_u32 s28, s28, 16384
    s_cmp_eq_u32 s7, 15
    s_cbranch_scc1 Lcb_7
    s_barrier
Lcb_7:
    s_cmp_eq_u32 s7, 15
    s_cbranch_scc1 Lcb_8
    s_barrier
Lcb_8:
    s_waitcnt vmcnt(0)
    s_mov_b64 exec, 1
    s_add_u32 s64, s68, 8192
    buffer_store_dword v10, off, s[52:55], s64
    s_mov_b64 exec, -1
    s_cmp_eq_u32 s7, 15
    s_cbranch_scc1 Lcb_9
    s_barrier
Lcb_9:
    s_add_u32 s65, s66, 8192
    s_waitcnt vmcnt(1)
    v_dot2_f32_bf16 v64, v16, v112, 0
    v_dot2_f32_bf16 v65, v20, v112, 0
    v_dot2_f32_bf16 v66, v24, v112, 0
    v_dot2_f32_bf16 v67, v28, v112, 0
    v_dot2_f32_bf16 v64, v17, v113, v64
    v_dot2_f32_bf16 v65, v21, v113, v65
    v_dot2_f32_bf16 v66, v25, v113, v66
    v_dot2_f32_bf16 v67, v29, v113, v67
    v_dot2_f32_bf16 v64, v18, v114, v64
    v_dot2_f32_bf16 v65, v22, v114, v65
    v_dot2_f32_bf16 v66, v26, v114, v66
    v_dot2_f32_bf16 v67, v30, v114, v67
    v_dot2_f32_bf16 v64, v19, v115, v64
    v_dot2_f32_bf16 v65, v23, v115, v65
    v_dot2_f32_bf16 v66, v27, v115, v66
    v_dot2_f32_bf16 v67, v31, v115, v67
    s_nop 1
    v_permlane32_swap_b32 v64, v66
    v_permlane32_swap_b32 v65, v67
    v_add_f32 v64, v64, v66
    v_add_f32 v65, v65, v67
    s_nop 1
    v_permlane16_swap_b32 v64, v65
    v_add_f32 v64, v64, v65
    s_nop 1
    v_add_f32_dpp v64, v64, v64 row_ror:8 row_mask:0xf bank_mask:0xf
    s_nop 1
    v_add_f32_dpp v64, v64, v64 row_ror:4 row_mask:0xf bank_mask:0xf
    s_nop 1
    v_add_f32_dpp v64, v64, v64 row_ror:2 row_mask:0xf bank_mask:0xf
    s_nop 1
    v_add_f32_dpp v64, v64, v64 row_ror:1 row_mask:0xf bank_mask:0xf
    v_mul_f32 v64, 0xbfb8aa3b, v64
    v_exp_f32 v64, v64
    s_nop 0
    v_add_f32 v64, 1.0, v64
    v_rcp_f32 v64, v64
    s_nop 0
    v_sub_f32 v65, 1.0, v64
    s_mov_b32 exec_lo, 0x00010001
    s_mov_b32 exec_hi, 0x00010001
    buffer_store_dwordx2 v[64:65], v38, s[52:55], s28 offen sc1
    s_mov_b64 exec, -1
    s_cmp_eq_u32 s7, 15
    s_cbranch_scc1 Lcb_10
    s_barrier
Lcb_10:
    buffer_load_dword v11, v12, s[52:55], s65 offen sc1
    s_cmp_eq_u32 s7, 15
    s_cbranch_scc1 Lcb_11
    s_barrier
Lcb_11:
    s_cmp_eq_u32 s7, 15
    s_cbranch_scc1 Lcb_12
    s_barrier
Lcb_12:
    s_waitcnt vmcnt(0)
    v_cmp_ne_u32 vcc, v11, v10
    s_nop 4
    s_cbranch_vccz Lok_13
    s_mov_b32 s64, 64
Lpoll_14:
    buffer_load_dword v11, v12, s[52:55], s65 offen sc1
    s_waitcnt vmcnt(0)
    v_cmp_ne_u32 vcc, v11, v10
    s_nop 4
    s_cbranch_vccz Lok_13
    s_sub_u32 s64, s64, 1
    s_cbranch_scc0 Lpoll_14
    s_lshl_b32 s63, s62, 7
    s_add_u32 s63, s63, 32784
    s_lshl2_add_u32 s63, s60, s63
    s_mov_b64 exec, 1
    buffer_store_dword v10, off, s[52:55], s63 sc1
    s_mov_b64 exec, -1
    v_lshrrev_b32 v2, 1, v1
    v_and_b32 v3, 4, v12
    v_lshl_add_u32 v2, v2, 7, v3
    s_lshl_b32 s65, s4, 12
    s_add_u32 s65, s65, 32784
    s_mov_b32 s64, 262144
Lpoll_15:
    buffer_load_dword v11, v2, s[52:55], s65 offen sc1
    s_waitcnt vmcnt(0)
    v_cmp_ne_u32 vcc, v11, v10
    s_nop 4
    s_cbranch_vccz Lok_13
    s_sub_u32 s64, s64, 1
    s_cbranch_scc0 Lpoll_15
Lok_13:
    s_mov_b64 exec, 1
    ds_add_u32 v14, v14 offset:0
    s_mov_b64 exec, -1
    s_lshl1_add_u32 s63, s62, s60
    s_lshl_b32 s63, s63, 12
    s_add_u32 s63, s63, 6291456
    buffer_load_dwordx4 v[16:19], v8, s[52:55], s63 offen offset:0 sc1
    buffer_load_dwordx4 v[20:23], v8, s[52:55], s63 offen offset:1024 sc1
    buffer_load_dwordx4 v[24:27], v8, s[52:55], s63 offen offset:2048 sc1
    buffer_load_dwordx4 v[28:31], v8, s[52:55], s63 offen offset:3072 sc1
    s_cmp_eq_u32 s7, 15
    s_cbranch_scc1 Lcb_16
    s_barrier
Lcb_16:
    s_waitcnt vmcnt(3)
    ds_write_b128 v37, v[16:19] offset:0
    s_waitcnt vmcnt(2)
    ds_write_b128 v37, v[20:23] offset:512
    s_waitcnt vmcnt(1)
    ds_write_b128 v37, v[24:27] offset:1024
    s_waitcnt vmcnt(0)
    ds_write_b128 v37, v[28:31] offset:1536
    s_waitcnt lgkmcnt(0)
    s_mov_b64 exec, 1
    ds_add_u32 v14, v14 offset:4
    s_mov_b64 exec, -1
    s_setprio 0
    s_lshl_b32 s66, s6, 7
    s_add_u32 s66, s66, 2048
    s_cmp_lg_u32 s60, 0
    s_cbranch_scc1 Lsk_19
    s_lshl_b32 s63, s62, 7
    s_add_u32 s63, s63, 32784
    s_mov_b64 exec, 3
    buffer_store_dword v10, v12, s[52:55], s63 offen sc1
    s_mov_b64 exec, -1
Lsk_19:
    v_and_b32 v7, 60, v12
Lw_20:
    ds_read_b32 v6, v14 offset:36
    s_sleep 1
    s_waitcnt lgkmcnt(0)
    v_readfirstlane_b32 s63, v6
    s_nop 0
    s_cmp_lg_u32 s63, 159744
    s_cbranch_scc1 Lw_20
    s_setprio 3
    s_cmp_lg_u32 s60, 0
    s_cbranch_scc1 Lsv1_17
    s_lshl_b32 s63, s62, 7
    s_add_u32 s63, s63, 32792
    s_mov_b64 exec, 1
    buffer_store_dword v10, off, s[52:55], s63 sc1
    s_mov_b64 exec, -1
    s_cmp_lg_u32 s2, 120
    s_cbranch_scc1 Lsvj_18
Lw_22:
    ds_read_b32 v6, v14 offset:28
    s_sleep 1
    s_waitcnt lgkmcnt(0)
    v_readfirstlane_b32 s63, v6
    s_nop 0
    s_cmp_lg_u32 s63, 638976
    s_cbranch_scc1 Lw_22
    v_lshlrev_b32 v2, 7, v1
    s_mov_b32 s64, 0x40000
Lepl_21:
    s_sub_u32 s64, s64, 1
    s_cbranch_scc1 Lsvj_18
    s_mov_b32 s63, 32784
    buffer_load_dwordx2 v[16:17], v2, s[52:55], s63 offen sc1
    s_mov_b32 s63, 40976
    buffer_load_dwordx2 v[18:19], v2, s[52:55], s63 offen sc1
    s_mov_b32 s63, 49168
    buffer_load_dwordx2 v[20:21], v2, s[52:55], s63 offen sc1
    s_mov_b32 s63, 57360
    buffer_load_dwordx2 v[22:23], v2, s[52:55], s63 offen sc1
    s_waitcnt vmcnt(0)
    v_xor_b32 v16, v16, v10
    v_xor_b32 v17, v17, v10
    v_or_b32 v16, v16, v17
    v_xor_b32 v18, v18, v10
    v_or_b32 v16, v16, v18
    v_xor_b32 v19, v19, v10
    v_or_b32 v16, v16, v19
    v_xor_b32 v20, v20, v10
    v_or_b32 v16, v16, v20
    v_xor_b32 v21, v21, v10
    v_or_b32 v16, v16, v21
    v_xor_b32 v22, v22, v10
    v_or_b32 v16, v16, v22
    v_xor_b32 v23, v23, v10
    v_or_b32 v16, v16, v23
    v_cmp_ne_u32 vcc, 0, v16
    s_nop 4
    s_cbranch_vccnz Lepl_21
    s_movk_i32 s63, 4096
    s_mov_b64 exec, 1
    buffer_store_dword v10, off, s[52:55], s63 sc1
    s_mov_b64 exec, -1
    s_mov_b32 s63, 131072
    s_mov_b64 exec, 1
    buffer_store_dword v39, off, s[52:55], s63 sc1
    s_mov_b64 exec, -1
    s_branch Lsvj_18
Lsv1_17:
    s_lshl_b32 s63, s6, 12
    s_add_u32 s63, s63, 65536
    s_add_u32 s65, s63, 4096
Lsp_24:
    s_load_dwordx16 s[12:27], s[52:53], s63
    s_add_u32 s63, s63, 128
    s_waitcnt lgkmcnt(0)
    s_xor_b64 s[12:13], s[12:13], s[30:31]
    s_xor_b64 s[14:15], s[14:15], s[30:31]
    s_xor_b64 s[16:17], s[16:17], s[30:31]
    s_xor_b64 s[18:19], s[18:19], s[30:31]
    s_xor_b64 s[20:21], s[20:21], s[30:31]
    s_xor_b64 s[22:23], s[22:23], s[30:31]
    s_xor_b64 s[24:25], s[24:25], s[30:31]
    s_xor_b64 s[26:27], s[26:27], s[30:31]
    s_or_b64 s[12:13], s[12:13], s[14:15]
    s_or_b64 s[16:17], s[16:17], s[18:19]
    s_or_b64 s[20:21], s[20:21], s[22:23]
    s_or_b64 s[24:25], s[24:25], s[26:27]
    s_or_b64 s[12:13], s[12:13], s[16:17]
    s_or_b64 s[20:21], s[20:21], s[24:25]
    s_or_b64 s[12:13], s[12:13], s[20:21]
    s_cbranch_scc0 Lall_23
    s_cmp_lt_u32 s63, s65
    s_cbranch_scc1 Lsp_24
    s_add_u32 s65, s66, 8192
    s_mov_b32 s64, 64
Lpoll_25:
    buffer_load_dword v11, v7, s[52:55], s65 offen sc1
    s_waitcnt vmcnt(0)
    v_cmp_ne_u32 vcc, v11, v10
    s_nop 4
    s_cbranch_vccz Lall_23
    s_sub_u32 s64, s64, 1
    s_cbranch_scc0 Lpoll_25
    v_lshlrev_b32 v2, 5, v7
    s_lshl_b32 s65, s6, 11
    s_add_u32 s65, s65, 32792
    s_mov_b32 s64, 262144
Lpoll_26:
    buffer_load_dword v11, v2, s[52:55], s65 offen sc1
    s_waitcnt vmcnt(0)
    v_cmp_ne_u32 vcc, v11, v10
    s_nop 4
    s_cbranch_vccz Lall_23
    s_sub_u32 s64, s64, 1
    s_cbranch_scc0 Lpoll_26
Lall_23:
    ds_write_b32 v14, v14 offset:12
Lsvj_18:
    s_waitcnt lgkmcnt(0)
    s_endpgm
L_conv:
    s_setprio 2
    s_sub_u32 s12, s3, 4
    s_lshr_b32 s13, s12, 1
    s_and_b32 s14, s12, 1
    s_lshl_b32 s62, s4, 5
    s_add_u32 s62, s62, s5
    s_and_b32 s7, s5, 15
    s_lshl_b32 s65, s14, 7
    s_sub_u32 s65, s65, 16
    v_add_u32 v5, 0, v1
    v_mul_u32_u24 v6, 187, v5
    v_lshrrev_b32 v6, 11, v6
    v_mad_u32_u24 v6, v6, 5, v1
    v_lshl_add_u32 v2, v6, 4, s65
    v_add_u32 v5, 64, v1
    v_mul_u32_u24 v6, 187, v5
    v_lshrrev_b32 v6, 11, v6
    v_mad_u32_u24 v6, v6, 5, v1
    v_lshl_add_u32 v3, v6, 4, s65
    v_add_u32 v5, 128, v1
    v_mul_u32_u24 v6, 187, v5
    v_lshrrev_b32 v6, 11, v6
    v_mad_u32_u24 v6, v6, 5, v1
    v_lshl_add_u32 v4, v6, 4, s65
    s_lshl1_add_u32 s66, s62, s13
    s_lshl_b32 s66, s66, 12
    s_mul_i32 s67, s12, 2816
    s_add_u32 s67, s67, 135168
    s_mov_b32 m0, s67
    s_movk_i32 s26, 4096
    s_mov_b32 s27, 0x20000
    s_waitcnt lgkmcnt(0)
    s_add_u32 s24, s94, s66
    s_addc_u32 s25, s95, 0
    s_load_dwordx2 s[52:53], s[0:1], 112
    s_load_dwordx2 s[60:61], s[0:1], 40
    buffer_load_dwordx4 v2, s[24:27], 0 offen lds
    buffer_load_dwordx4 v3, s[24:27], 0 offen offset:1024 lds
    s_mov_b32 exec_hi, 0xffff
    buffer_load_dwordx4 v4, s[24:27], 0 offen offset:2048 lds
    s_mov_b32 exec_hi, -1
    s_mov_b32 s54, 268435456
    s_mov_b32 s55, 0x20000
    v_lshlrev_b32 v8, 4, v1
    v_mov_b32 v9, 159744
    v_bfe_u32 v5, v1, 1, 1
    v_mul_u32_u24 v5, 44, v5
    v_lshrrev_b32 v6, 2, v1
    v_and_b32 v7, 1, v1
    v_add3_u32 v5, v5, v6, v7
    v_lshl_add_u32 v126, v5, 2, s67
    s_lshl_b32 s64, s62, 2
    s_waitcnt lgkmcnt(0)
    s_load_dword s59, s[60:61], s64
    s_load_dword s58, s[52:53], 4096
    s_load_dword s96, s[52:53], 131072
    v_xor_b32 v7, 1, v7
    v_lshlrev_b32 v7, 4, v7
    v_and_b32 v2, 15, v1
    v_lshrrev_b32 v3, 4, v1
    v_sub_u32 v124, v2, v3
    v_lshlrev_b32 v124, 4, v124
    s_mul_i32 s63, s13, 4352
    s_add_u32 s63, s63, 147712
    s_lshl_b32 s65, s14, 7
    s_sub_u32 s65, s63, s65
    s_sub_u32 s65, s65, 64
    v_add_u32 v124, s65, v124
    v_lshlrev_b32 v125, 4, v2
    v_lshlrev_b32 v3, 2, v3
    v_sub_u32 v125, v125, v3
    s_lshl_b32 s64, s14, 11
    s_add_u32 s63, s63, s64
    s_add_u32 s63, s63, 12
    v_add_u32 v125, s63, v125
    s_lshl_b32 s63, s12, 12
    s_add_u32 s63, s63, 131072
    v_add_u32 v2, s63, v8
    v_xor_b32 v3, 4096, v2
    v_add_u32 v4, 1056, v126
    v_add_u32 v5, 2112, v126
    s_lshl_b32 s64, s14, 11
    s_add_u32 s15, s66, s64
    s_add_u32 s15, s15, 8388608
    s_lshl_b32 s16, s62, 7
    s_lshl2_add_u32 s16, s12, s16
    s_add_u32 s16, s16, 32768
    s_waitcnt lgkmcnt(0)
    s_lshl_b32 s63, s13, 4
    s_lshr_b32 s59, s59, s63
    s_lshl_b32 s59, s59, 16
    s_add_u32 s17, s58, s96
    s_add_u32 s17, s17, 2654435761
    s_barrier
    s_waitcnt vmcnt(0)
    ds_read2_b32 v[10:11], v126 offset0:0 offset1:1
    ds_read2_b32 v[12:13], v126 offset0:2 offset1:3
    ds_read_b32 v74, v126 offset:16
    ds_read2_b32 v[14:15], v126 offset0:16 offset1:17
    ds_read2_b32 v[16:17], v126 offset0:18 offset1:19
    ds_read_b32 v75, v126 offset:80
    ds_read2_b32 v[18:19], v126 offset0:88 offset1:89
    ds_read2_b32 v[20:21], v126 offset0:90 offset1:91
    ds_read_b32 v76, v126 offset:368
    ds_read2_b32 v[22:23], v126 offset0:104 offset1:105
    ds_read2_b32 v[24:25], v126 offset0:106 offset1:107
    ds_read_b32 v77, v126 offset:432
    ds_read2_b32 v[26:27], v126 offset0:176 offset1:177
    ds_read2_b32 v[28:29], v126 offset0:178 offset1:179
    ds_read_b32 v78, v126 offset:720
    ds_read2_b32 v[30:31], v126 offset0:192 offset1:193
    ds_read2_b32 v[32:33], v126 offset0:194 offset1:195
    ds_read_b32 v79, v126 offset:784
    ds_read2_b32 v[34:35], v4 offset0:0 offset1:1
    ds_read2_b32 v[36:37], v4 offset0:2 offset1:3
    ds_read_b32 v80, v4 offset:16
    ds_read2_b32 v[38:39], v4 offset0:16 offset1:17
    ds_read2_b32 v[40:41], v4 offset0:18 offset1:19
    ds_read_b32 v81, v4 offset:80
    ds_read2_b32 v[42:43], v4 offset0:88 offset1:89
    ds_read2_b32 v[44:45], v4 offset0:90 offset1:91
    ds_read_b32 v82, v4 offset:368
    ds_read2_b32 v[46:47], v4 offset0:104 offset1:105
    ds_read2_b32 v[48:49], v4 offset0:106 offset1:107
    ds_read_b32 v83, v4 offset:432
    ds_read2_b32 v[50:51], v4 offset0:176 offset1:177
    ds_read2_b32 v[52:53], v4 offset0:178 offset1:179
    ds_read_b32 v84, v4 offset:720
    ds_read2_b32 v[54:55], v4 offset0:192 offset1:193
    ds_read2_b32 v[56:57], v4 offset0:194 offset1:195
    ds_read_b32 v85, v4 offset:784
    ds_read2_b32 v[58:59], v5 offset0:0 offset1:1
    ds_read2_b32 v[60:61], v5 offset0:2 offset1:3
    ds_read_b32 v86, v5 offset:16
    ds_read2_b32 v[62:63], v5 offset0:16 offset1:17
    ds_read2_b32 v[64:65], v5 offset0:18 offset1:19
    ds_read_b32 v87, v5 offset:80
    ds_read2_b32 v[66:67], v5 offset0:88 offset1:89
    ds_read2_b32 v[68:69], v5 offset0:90 offset1:91
    ds_read_b32 v88, v5 offset:368
    ds_read2_b32 v[70:71], v5 offset0:104 offset1:105
    ds_read2_b32 v[72:73], v5 offset0:106 offset1:107
    ds_read_b32 v89, v5 offset:432
    s_waitcnt lgkmcnt(0)
    v_alignbit_b32 v10, v11, v10, v7
    v_alignbit_b32 v14, v15, v14, v7
    v_alignbit_b32 v18, v19, v18, v7
    v_alignbit_b32 v22, v23, v22, v7
    v_alignbit_b32 v26, v27, v26, v7
    v_alignbit_b32 v30, v31, v30, v7
    v_alignbit_b32 v34, v35, v34, v7
    v_alignbit_b32 v38, v39, v38, v7
    v_alignbit_b32 v42, v43, v42, v7
    v_alignbit_b32 v46, v47, v46, v7
    v_alignbit_b32 v50, v51, v50, v7
    v_alignbit_b32 v54, v55, v54, v7
    v_alignbit_b32 v58, v59, v58, v7
    v_alignbit_b32 v62, v63, v62, v7
    v_alignbit_b32 v66, v67, v66, v7
    v_alignbit_b32 v70, v71, v70, v7
    v_alignbit_b32 v11, v12, v11, v7
    v_alignbit_b32 v15, v16, v15, v7
    v_alignbit_b32 v19, v20, v19, v7
    v_alignbit_b32 v23, v24, v23, v7
    v_alignbit_b32 v27, v28, v27, v7
    v_alignbit_b32 v31, v32, v31, v7
    v_alignbit_b32 v35, v36, v35, v7
    v_alignbit_b32 v39, v40, v39, v7
    v_alignbit_b32 v43, v44, v43, v7
    v_alignbit_b32 v47, v48, v47, v7
    v_alignbit_b32 v51, v52, v51, v7
    v_alignbit_b32 v55, v56, v55, v7
    v_alignbit_b32 v59, v60, v59, v7
    v_alignbit_b32 v63, v64, v63, v7
    v_alignbit_b32 v67, v68, v67, v7
    v_alignbit_b32 v71, v72, v71, v7
    v_alignbit_b32 v12, v13, v12, v7
    v_alignbit_b32 v16, v17, v16, v7
    v_alignbit_b32 v20, v21, v20, v7
    v_alignbit_b32 v24, v25, v24, v7
    v_alignbit_b32 v28, v29, v28, v7
    v_alignbit_b32 v32, v33, v32, v7
    v_alignbit_b32 v36, v37, v36, v7
    v_alignbit_b32 v40, v41, v40, v7
    v_alignbit_b32 v44, v45, v44, v7
    v_alignbit_b32 v48, v49, v48, v7
    v_alignbit_b32 v52, v53, v52, v7
    v_alignbit_b32 v56, v57, v56, v7
    v_alignbit_b32 v60, v61, v60, v7
    v_alignbit_b32 v64, v65, v64, v7
    v_alignbit_b32 v68, v69, v68, v7
    v_alignbit_b32 v72, v73, v72, v7
    v_alignbit_b32 v13, v74, v13, v7
    v_alignbit_b32 v17, v75, v17, v7
    v_alignbit_b32 v21, v76, v21, v7
    v_alignbit_b32 v25, v77, v25, v7
    v_alignbit_b32 v29, v78, v29, v7
    v_alignbit_b32 v33, v79, v33, v7
    v_alignbit_b32 v37, v80, v37, v7
    v_alignbit_b32 v41, v81, v41, v7
    v_alignbit_b32 v45, v82, v45, v7
    v_alignbit_b32 v49, v83, v49, v7
    v_alignbit_b32 v53, v84, v53, v7
    v_alignbit_b32 v57, v85, v57, v7
    v_alignbit_b32 v61, v86, v61, v7
    v_alignbit_b32 v65, v87, v65, v7
    v_alignbit_b32 v69, v88, v69, v7
    v_alignbit_b32 v73, v89, v73, v7
    s_cmp_eq_u32 s7, 15
    s_cbranch_scc1 Lcb_27
    s_barrier
Lcb_27:
    s_cmp_eq_u32 s7, 15
    s_cbranch_scc1 Lcb_28
    s_barrier
Lcb_28:
    s_cmp_eq_u32 s7, 15
    s_cbranch_scc1 Lcb_29
    s_barrier
Lcb_29:
    s_cmp_eq_u32 s7, 15
    s_cbranch_scc1 Lcb_30
    s_barrier
Lcb_30:
    s_cmp_eq_u32 s7, 15
    s_cbranch_scc1 Lcb_31
    s_barrier
Lcb_31:
    s_cmp_eq_u32 s7, 15
    s_cbranch_scc1 Lcb_32
    s_barrier
Lcb_32:
    s_cmp_eq_u32 s7, 15
    s_cbranch_scc1 Lcb_33
    s_barrier
Lcb_33:
    s_cmp_eq_u32 s7, 15
    s_cbranch_scc1 Lcb_34
    s_barrier
Lcb_34:
    s_setprio 0
    s_mov_b64 exec, 1
    ds_add_u32 v9, v9 offset:4
    s_mov_b64 exec, -1
    v_mov_b32 v74, 0
    v_mov_b32 v75, 0
    v_mov_b32 v76, 0
    v_mov_b32 v77, 0
    v_mov_b32 v78, 0
    v_mov_b32 v79, 0
    v_mov_b32 v80, 0
    v_mov_b32 v81, 0
    v_mov_b32 v82, 0
    v_mov_b32 v83, 0
    v_mov_b32 v84, 0
    v_mov_b32 v85, 0
    v_mov_b32 v86, 0
    v_mov_b32 v87, 0
    v_mov_b32 v88, 0
    v_mov_b32 v89, 0
    v_mov_b32 v90, 0
    v_mov_b32 v91, 0
    v_mov_b32 v92, 0
    v_mov_b32 v93, 0
    v_mov_b32 v94, 0
    v_mov_b32 v95, 0
    v_mov_b32 v96, 0
    v_mov_b32 v97, 0
    v_mov_b32 v98, 0
    v_mov_b32 v99, 0
    v_mov_b32 v100, 0
    v_mov_b32 v101, 0
    v_mov_b32 v102, 0
    v_mov_b32 v103, 0
    v_mov_b32 v104, 0
    v_mov_b32 v105, 0
    v_mov_b32 v106, 0
    v_mov_b32 v107, 0
    s_lshl2_add_u32 s18, s13, 159764
    v_mov_b32 v4, s18
    s_lshl_b32 s18, s18, 1
    v_mov_b32 v5, s17
Lw_35:
    ds_read_b32 v6, v9 offset:4
    s_sleep 1
    s_waitcnt lgkmcnt(0)
    v_readfirstlane_b32 s63, v6
    s_nop 0
    s_cmp_lg_u32 s63, 958464
    s_cbranch_scc1 Lw_35
    ds_read_b32 v108, v125 offset:0
    ds_read_b32 v109, v125 offset:256
    ds_read_b32 v110, v125 offset:512
    ds_read_b32 v111, v125 offset:768
    ds_read_b32 v112, v125 offset:1024
    ds_read_b32 v113, v125 offset:1280
    ds_read_b32 v114, v125 offset:1536
    ds_read_b32 v115, v125 offset:1792
    s_cmp_eq_u32 s14, 1
    s_waitcnt lgkmcnt(0)
    s_cbranch_scc1 Lk1_36
    v_and_b32 v74, 0xffff0000, v108
    v_lshlrev_b32 v75, 16, v108
    v_and_b32 v76, 0xffff0000, v109
    v_lshlrev_b32 v77, 16, v109
    v_and_b32 v78, 0xffff0000, v110
    v_lshlrev_b32 v79, 16, v110
    v_and_b32 v80, 0xffff0000, v111
    v_lshlrev_b32 v81, 16, v111
    v_and_b32 v82, 0xffff0000, v112
    v_lshlrev_b32 v83, 16, v112
    v_and_b32 v84, 0xffff0000, v113
    v_lshlrev_b32 v85, 16, v113
    v_and_b32 v86, 0xffff0000, v114
    v_lshlrev_b32 v87, 16, v114
    v_and_b32 v88, 0xffff0000, v115
    v_lshlrev_b32 v89, 16, v115
    v_mul_f32 v74, s59, v74
    v_mul_f32 v75, s59, v75
    v_mul_f32 v76, s59, v76
    v_mul_f32 v77, s59, v77
    v_mul_f32 v78, s59, v78
    v_mul_f32 v79, s59, v79
    v_mul_f32 v80, s59, v80
    v_mul_f32 v81, s59, v81
    v_mul_f32 v82, s59, v82
    v_mul_f32 v83, s59, v83
    v_mul_f32 v84, s59, v84
    v_mul_f32 v85, s59, v85
    v_mul_f32 v86, s59, v86
    v_mul_f32 v87, s59, v87
    v_mul_f32 v88, s59, v88
    v_mul_f32 v89, s59, v89
    s_branch Lk2_37
Lk1_36:
    v_and_b32 v90, 0xffff0000, v108
    v_lshlrev_b32 v91, 16, v108
    v_and_b32 v92, 0xffff0000, v109
    v_lshlrev_b32 v93, 16, v109
    v_and_b32 v94, 0xffff0000, v110
    v_lshlrev_b32 v95, 16, v110
    v_and_b32 v96, 0xffff0000, v111
    v_lshlrev_b32 v97, 16, v111
    v_and_b32 v98, 0xffff0000, v112
    v_lshlrev_b32 v99, 16, v112
    v_and_b32 v100, 0xffff0000, v113
    v_lshlrev_b32 v101, 16, v113
    v_and_b32 v102, 0xffff0000, v114
    v_lshlrev_b32 v103, 16, v114
    v_and_b32 v104, 0xffff0000, v115
    v_lshlrev_b32 v105, 16, v115
    v_mul_f32 v90, s59, v90
    v_mul_f32 v91, s59, v91
    v_mul_f32 v92, s59, v92
    v_mul_f32 v93, s59, v93
    v_mul_f32 v94, s59, v94
    v_mul_f32 v95, s59, v95
    v_mul_f32 v96, s59, v96
    v_mul_f32 v97, s59, v97
    v_mul_f32 v98, s59, v98
    v_mul_f32 v99, s59, v99
    v_mul_f32 v100, s59, v100
    v_mul_f32 v101, s59, v101
    v_mul_f32 v102, s59, v102
    v_mul_f32 v103, s59, v103
    v_mul_f32 v104, s59, v104
    v_mul_f32 v105, s59, v105
Lk2_37:
    ds_read_b128 v[108:111], v124 offset:64
    ds_read_b128 v[112:115], v124 offset:0
    ds_read_b128 v[116:119], v124 offset:3648
    ds_read_b128 v[120:123], v124 offset:3584
Lw_38:
    ds_read_b32 v6, v9 offset:8
    s_sleep 1
    s_waitcnt lgkmcnt(0)
    v_readfirstlane_b32 s63, v6
    s_nop 0
    s_cmp_lg_u32 s63, 1277952
    s_cbranch_scc1 Lw_38
    s_setprio 3
    v_mfma_f32_16x16x32_bf16 v[74:77], v[10:13], v[108:111], v[74:77]
    v_mfma_f32_16x16x32_bf16 v[78:81], v[18:21], v[108:111], v[78:81]
    v_mfma_f32_16x16x32_bf16 v[82:85], v[26:29], v[108:111], v[82:85]
    v_mfma_f32_16x16x32_bf16 v[86:89], v[34:37], v[108:111], v[86:89]
    v_mfma_f32_16x16x32_bf16 v[90:93], v[42:45], v[108:111], v[90:93]
    v_mfma_f32_16x16x32_bf16 v[94:97], v[50:53], v[108:111], v[94:97]
    v_mfma_f32_16x16x32_bf16 v[98:101], v[58:61], v[108:111], v[98:101]
    v_mfma_f32_16x16x32_bf16 v[102:105], v[66:69], v[108:111], v[102:105]
    ds_read_b128 v[108:111], v124 offset:576
    v_mfma_f32_16x16x32_bf16 v[74:77], v[14:17], v[112:115], v[74:77]
    v_mfma_f32_16x16x32_bf16 v[78:81], v[22:25], v[112:115], v[78:81]
    v_mfma_f32_16x16x32_bf16 v[82:85], v[30:33], v[112:115], v[82:85]
    v_mfma_f32_16x16x32_bf16 v[86:89], v[38:41], v[112:115], v[86:89]
    v_mfma_f32_16x16x32_bf16 v[90:93], v[46:49], v[112:115], v[90:93]
    v_mfma_f32_16x16x32_bf16 v[94:97], v[54:57], v[112:115], v[94:97]
    v_mfma_f32_16x16x32_bf16 v[98:101], v[62:65], v[112:115], v[98:101]
    v_mfma_f32_16x16x32_bf16 v[102:105], v[70:73], v[112:115], v[102:105]
    ds_read_b128 v[112:115], v124 offset:512
    v_mfma_f32_16x16x32_bf16 v[102:105], v[10:13], v[116:119], v[102:105]
    ds_read_b128 v[116:119], v124 offset:3136
    v_mfma_f32_16x16x32_bf16 v[102:105], v[14:17], v[120:123], v[102:105]
    ds_read_b128 v[120:123], v124 offset:3072
    s_waitcnt lgkmcnt(3)
    v_mfma_f32_16x16x32_bf16 v[78:81], v[10:13], v[108:111], v[78:81]
    v_mfma_f32_16x16x32_bf16 v[82:85], v[18:21], v[108:111], v[82:85]
    v_mfma_f32_16x16x32_bf16 v[86:89], v[26:29], v[108:111], v[86:89]
    v_mfma_f32_16x16x32_bf16 v[90:93], v[34:37], v[108:111], v[90:93]
    v_mfma_f32_16x16x32_bf16 v[94:97], v[42:45], v[108:111], v[94:97]
    v_mfma_f32_16x16x32_bf16 v[98:101], v[50:53], v[108:111], v[98:101]
    v_mfma_f32_16x16x32_bf16 v[102:105], v[58:61], v[108:111], v[102:105]
    ds_read_b128 v[108:111], v124 offset:1088
    s_waitcnt lgkmcnt(3)
    v_mfma_f32_16x16x32_bf16 v[78:81], v[14:17], v[112:115], v[78:81]
    v_mfma_f32_16x16x32_bf16 v[82:85], v[22:25], v[112:115], v[82:85]
    v_mfma_f32_16x16x32_bf16 v[86:89], v[30:33], v[112:115], v[86:89]
    v_mfma_f32_16x16x32_bf16 v[90:93], v[38:41], v[112:115], v[90:93]
    v_mfma_f32_16x16x32_bf16 v[94:97], v[46:49], v[112:115], v[94:97]
    v_mfma_f32_16x16x32_bf16 v[98:101], v[54:57], v[112:115], v[98:101]
    v_mfma_f32_16x16x32_bf16 v[102:105], v[62:65], v[112:115], v[102:105]
    ds_read_b128 v[112:115], v124 offset:1024
    s_waitcnt lgkmcnt(3)
    v_mfma_f32_16x16x32_bf16 v[98:101], v[10:13], v[116:119], v[98:101]
    v_mfma_f32_16x16x32_bf16 v[102:105], v[18:21], v[116:119], v[102:105]
    ds_read_b128 v[116:119], v124 offset:2624
    s_waitcnt lgkmcnt(3)
    v_mfma_f32_16x16x32_bf16 v[98:101], v[14:17], v[120:123], v[98:101]
    v_mfma_f32_16x16x32_bf16 v[102:105], v[22:25], v[120:123], v[102:105]
    ds_read_b128 v[120:123], v124 offset:2560
    s_waitcnt lgkmcnt(3)
    v_mfma_f32_16x16x32_bf16 v[82:85], v[10:13], v[108:111], v[82:85]
    v_mfma_f32_16x16x32_bf16 v[86:89], v[18:21], v[108:111], v[86:89]
    v_mfma_f32_16x16x32_bf16 v[90:93], v[26:29], v[108:111], v[90:93]
    v_mfma_f32_16x16x32_bf16 v[94:97], v[34:37], v[108:111], v[94:97]
    v_mfma_f32_16x16x32_bf16 v[98:101], v[42:45], v[108:111], v[98:101]
    v_mfma_f32_16x16x32_bf16 v[102:105], v[50:53], v[108:111], v[102:105]
    ds_read_b128 v[108:111], v124 offset:1600
    s_waitcnt lgkmcnt(3)
    v_mfma_f32_16x16x32_bf16 v[82:85], v[14:17], v[112:115], v[82:85]
    v_mfma_f32_16x16x32_bf16 v[86:89], v[22:25], v[112:115], v[86:89]
    v_mfma_f32_16x16x32_bf16 v[90:93], v[30:33], v[112:115], v[90:93]
    v_mfma_f32_16x16x32_bf16 v[94:97], v[38:41], v[112:115], v[94:97]
    v_mfma_f32_16x16x32_bf16 v[98:101], v[46:49], v[112:115], v[98:101]
    v_mfma_f32_16x16x32_bf16 v[102:105], v[54:57], v[112:115], v[102:105]
    ds_read_b128 v[112:115], v124 offset:1536
    s_waitcnt lgkmcnt(3)
    v_mfma_f32_16x16x32_bf16 v[94:97], v[10:13], v[116:119], v[94:97]
    v_mfma_f32_16x16x32_bf16 v[98:101], v[18:21], v[116:119], v[98:101]
    v_mfma_f32_16x16x32_bf16 v[102:105], v[26:29], v[116:119], v[102:105]
    ds_read_b128 v[116:119], v124 offset:2112
    s_waitcnt lgkmcnt(3)
    v_mfma_f32_16x16x32_bf16 v[94:97], v[14:17], v[120:123], v[94:97]
    v_mfma_f32_16x16x32_bf16 v[98:101], v[22:25], v[120:123], v[98:101]
    v_mfma_f32_16x16x32_bf16 v[102:105], v[30:33], v[120:123], v[102:105]
    ds_read_b128 v[120:123], v124 offset:2048
    s_waitcnt lgkmcnt(3)
    v_mfma_f32_16x16x32_bf16 v[86:89], v[10:13], v[108:111], v[86:89]
    v_mfma_f32_16x16x32_bf16 v[90:93], v[18:21], v[108:111], v[90:93]
    v_mfma_f32_16x16x32_bf16 v[94:97], v[26:29], v[108:111], v[94:97]
    v_mfma_f32_16x16x32_bf16 v[98:101], v[34:37], v[108:111], v[98:101]
    v_mfma_f32_16x16x32_bf16 v[102:105], v[42:45], v[108:111], v[102:105]
    ds_read_b128 v[108:111], v124 offset:320
    s_waitcnt lgkmcnt(3)
    v_mfma_f32_16x16x32_bf16 v[86:89], v[14:17], v[112:115], v[86:89]
    v_mfma_f32_16x16x32_bf16 v[90:93], v[22:25], v[112:115], v[90:93]
    v_mfma_f32_16x16x32_bf16 v[94:97], v[30:33], v[112:115], v[94:97]
    v_mfma_f32_16x16x32_bf16 v[98:101], v[38:41], v[112:115], v[98:101]
    v_mfma_f32_16x16x32_bf16 v[102:105], v[46:49], v[112:115], v[102:105]
    ds_read_b128 v[112:115], v124 offset:256
    s_waitcnt lgkmcnt(3)
    v_mfma_f32_16x16x32_bf16 v[90:93], v[10:13], v[116:119], v[90:93]
    v_mfma_f32_16x16x32_bf16 v[94:97], v[18:21], v[116:119], v[94:97]
    v_mfma_f32_16x16x32_bf16 v[98:101], v[26:29], v[116:119], v[98:101]
    v_mfma_f32_16x16x32_bf16 v[102:105], v[34:37], v[116:119], v[102:105]
    ds_read_b128 v[116:119], v124 offset:3904
    s_waitcnt lgkmcnt(3)
    v_mfma_f32_16x16x32_bf16 v[90:93], v[14:17], v[120:123], v[90:93]
    v_mfma_f32_16x16x32_bf16 v[94:97], v[22:25], v[120:123], v[94:97]
    v_mfma_f32_16x16x32_bf16 v[98:101], v[30:33], v[120:123], v[98:101]
    v_mfma_f32_16x16x32_bf16 v[102:105], v[38:41], v[120:123], v[102:105]
    ds_read_b128 v[120:123], v124 offset:3840
    s_waitcnt lgkmcnt(3)
    v_mfma_f32_16x16x32_bf16 v[76:79], v[10:13], v[108:111], v[76:79]
    v_mfma_f32_16x16x32_bf16 v[80:83], v[18:21], v[108:111], v[80:83]
    v_mfma_f32_16x16x32_bf16 v[84:87], v[26:29], v[108:111], v[84:87]
    v_mfma_f32_16x16x32_bf16 v[88:91], v[34:37], v[108:111], v[88:91]
    v_mfma_f32_16x16x32_bf16 v[92:95], v[42:45], v[108:111], v[92:95]
    v_mfma_f32_16x16x32_bf16 v[96:99], v[50:53], v[108:111], v[96:99]
    v_mfma_f32_16x16x32_bf16 v[100:103], v[58:61], v[108:111], v[100:103]
    v_mfma_f32_16x16x32_bf16 v[104:107], v[66:69], v[108:111], v[104:107]
    ds_read_b128 v[108:111], v124 offset:832
    s_waitcnt lgkmcnt(3)
    v_mfma_f32_16x16x32_bf16 v[76:79], v[14:17], v[112:115], v[76:79]
    v_mfma_f32_16x16x32_bf16 v[80:83], v[22:25], v[112:115], v[80:83]
    v_mfma_f32_16x16x32_bf16 v[84:87], v[30:33], v[112:115], v[84:87]
    v_mfma_f32_16x16x32_bf16 v[88:91], v[38:41], v[112:115], v[88:91]
    v_mfma_f32_16x16x32_bf16 v[92:95], v[46:49], v[112:115], v[92:95]
    v_mfma_f32_16x16x32_bf16 v[96:99], v[54:57], v[112:115], v[96:99]
    v_mfma_f32_16x16x32_bf16 v[100:103], v[62:65], v[112:115], v[100:103]
    v_mfma_f32_16x16x32_bf16 v[104:107], v[70:73], v[112:115], v[104:107]
    ds_read_b128 v[112:115], v124 offset:768
    s_waitcnt lgkmcnt(3)
    v_mfma_f32_16x16x32_bf16 v[104:107], v[10:13], v[116:119], v[104:107]
    ds_read_b128 v[116:119], v124 offset:3392
    s_waitcnt lgkmcnt(3)
    v_mfma_f32_16x16x32_bf16 v[104:107], v[14:17], v[120:123], v[104:107]
    ds_read_b128 v[120:123], v124 offset:3328
    s_waitcnt lgkmcnt(3)
    v_mfma_f32_16x16x32_bf16 v[80:83], v[10:13], v[108:111], v[80:83]
    v_mfma_f32_16x16x32_bf16 v[84:87], v[18:21], v[108:111], v[84:87]
    v_mfma_f32_16x16x32_bf16 v[88:91], v[26:29], v[108:111], v[88:91]
    v_mfma_f32_16x16x32_bf16 v[92:95], v[34:37], v[108:111], v[92:95]
    v_mfma_f32_16x16x32_bf16 v[96:99], v[42:45], v[108:111], v[96:99]
    v_mfma_f32_16x16x32_bf16 v[100:103], v[50:53], v[108:111], v[100:103]
    v_mfma_f32_16x16x32_bf16 v[104:107], v[58:61], v[108:111], v[104:107]
    ds_read_b128 v[108:111], v124 offset:1344
    s_waitcnt lgkmcnt(3)
    v_mfma_f32_16x16x32_bf16 v[80:83], v[14:17], v[112:115], v[80:83]
    v_mfma_f32_16x16x32_bf16 v[84:87], v[22:25], v[112:115], v[84:87]
    v_mfma_f32_16x16x32_bf16 v[88:91], v[30:33], v[112:115], v[88:91]
    v_mfma_f32_16x16x32_bf16 v[92:95], v[38:41], v[112:115], v[92:95]
    v_mfma_f32_16x16x32_bf16 v[96:99], v[46:49], v[112:115], v[96:99]
    v_mfma_f32_16x16x32_bf16 v[100:103], v[54:57], v[112:115], v[100:103]
    v_mfma_f32_16x16x32_bf16 v[104:107], v[62:65], v[112:115], v[104:107]
    ds_read_b128 v[112:115], v124 offset:1280
    s_waitcnt lgkmcnt(3)
    v_mfma_f32_16x16x32_bf16 v[100:103], v[10:13], v[116:119], v[100:103]
    v_mfma_f32_16x16x32_bf16 v[104:107], v[18:21], v[116:119], v[104:107]
    ds_read_b128 v[116:119], v124 offset:2880
    s_waitcnt lgkmcnt(3)
    v_mfma_f32_16x16x32_bf16 v[100:103], v[14:17], v[120:123], v[100:103]
    v_mfma_f32_16x16x32_bf16 v[104:107], v[22:25], v[120:123], v[104:107]
    ds_read_b128 v[120:123], v124 offset:2816
    s_waitcnt lgkmcnt(3)
    v_mfma_f32_16x16x32_bf16 v[84:87], v[10:13], v[108:111], v[84:87]
    v_mfma_f32_16x16x32_bf16 v[88:91], v[18:21], v[108:111], v[88:91]
    v_mfma_f32_16x16x32_bf16 v[92:95], v[26:29], v[108:111], v[92:95]
    v_mfma_f32_16x16x32_bf16 v[96:99], v[34:37], v[108:111], v[96:99]
    v_mfma_f32_16x16x32_bf16 v[100:103], v[42:45], v[108:111], v[100:103]
    v_mfma_f32_16x16x32_bf16 v[104:107], v[50:53], v[108:111], v[104:107]
    ds_read_b128 v[108:111], v124 offset:1856
    s_waitcnt lgkmcnt(3)
    v_mfma_f32_16x16x32_bf16 v[84:87], v[14:17], v[112:115], v[84:87]
    v_mfma_f32_16x16x32_bf16 v[88:91], v[22:25], v[112:115], v[88:91]
    v_mfma_f32_16x16x32_bf16 v[92:95], v[30:33], v[112:115], v[92:95]
    v_mfma_f32_16x16x32_bf16 v[96:99], v[38:41], v[112:115], v[96:99]
    v_mfma_f32_16x16x32_bf16 v[100:103], v[46:49], v[112:115], v[100:103]
    v_mfma_f32_16x16x32_bf16 v[104:107], v[54:57], v[112:115], v[104:107]
    ds_read_b128 v[112:115], v124 offset:1792
    s_waitcnt lgkmcnt(3)
    v_mfma_f32_16x16x32_bf16 v[96:99], v[10:13], v[116:119], v[96:99]
    v_mfma_f32_16x16x32_bf16 v[100:103], v[18:21], v[116:119], v[100:103]
    v_mfma_f32_16x16x32_bf16 v[104:107], v[26:29], v[116:119], v[104:107]
    ds_read_b128 v[116:119], v124 offset:2368
    s_waitcnt lgkmcnt(3)
    v_mfma_f32_16x16x32_bf16 v[96:99], v[14:17], v[120:123], v[96:99]
    v_mfma_f32_16x16x32_bf16 v[100:103], v[22:25], v[120:123], v[100:103]
    v_mfma_f32_16x16x32_bf16 v[104:107], v[30:33], v[120:123], v[104:107]
    ds_read_b128 v[120:123], v124 offset:2304
    s_waitcnt lgkmcnt(3)
    v_mfma_f32_16x16x32_bf16 v[88:91], v[10:13], v[108:111], v[88:91]
    v_mfma_f32_16x16x32_bf16 v[92:95], v[18:21], v[108:111], v[92:95]
    v_mfma_f32_16x16x32_bf16 v[96:99], v[26:29], v[108:111], v[96:99]
    v_mfma_f32_16x16x32_bf16 v[100:103], v[34:37], v[108:111], v[100:103]
    v_mfma_f32_16x16x32_bf16 v[104:107], v[42:45], v[108:111], v[104:107]
    s_waitcnt lgkmcnt(2)
    v_mfma_f32_16x16x32_bf16 v[88:91], v[14:17], v[112:115], v[88:91]
    v_mfma_f32_16x16x32_bf16 v[92:95], v[22:25], v[112:115], v[92:95]
    v_mfma_f32_16x16x32_bf16 v[96:99], v[30:33], v[112:115], v[96:99]
    v_mfma_f32_16x16x32_bf16 v[100:103], v[38:41], v[112:115], v[100:103]
    v_mfma_f32_16x16x32_bf16 v[104:107], v[46:49], v[112:115], v[104:107]
    s_waitcnt lgkmcnt(1)
    v_mfma_f32_16x16x32_bf16 v[92:95], v[10:13], v[116:119], v[92:95]
    v_mfma_f32_16x16x32_bf16 v[96:99], v[18:21], v[116:119], v[96:99]
    v_mfma_f32_16x16x32_bf16 v[100:103], v[26:29], v[116:119], v[100:103]
    v_mfma_f32_16x16x32_bf16 v[104:107], v[34:37], v[116:119], v[104:107]
    s_waitcnt lgkmcnt(0)
    v_mfma_f32_16x16x32_bf16 v[92:95], v[14:17], v[120:123], v[92:95]
    v_mfma_f32_16x16x32_bf16 v[96:99], v[22:25], v[120:123], v[96:99]
    v_mfma_f32_16x16x32_bf16 v[100:103], v[30:33], v[120:123], v[100:103]
    v_mfma_f32_16x16x32_bf16 v[104:107], v[38:41], v[120:123], v[104:107]
    s_cmp_eq_u32 s14, 1
    s_cbranch_scc1 Lk1_39
    s_nop 2
    ds_write_b128 v2, v[90:93] offset:0
    ds_write_b128 v2, v[94:97] offset:1024
    ds_write_b128 v2, v[98:101] offset:2048
    ds_write_b128 v2, v[102:105] offset:3072
    s_waitcnt lgkmcnt(0)
    s_mov_b64 exec, 1
    ds_add_u32 v4, v4 offset:0
    s_mov_b64 exec, -1
Lw_41:
    ds_read_b32 v6, v4 offset:0
    s_waitcnt lgkmcnt(0)
    v_readfirstlane_b32 s63, v6
    s_nop 0
    s_cmp_lg_u32 s63, s18
    s_cbranch_scc1 Lw_41
    ds_read_b128 v[42:45], v3 offset:0
    ds_read_b128 v[46:49], v3 offset:1024
    ds_read_b128 v[50:53], v3 offset:2048
    ds_read_b128 v[54:57], v3 offset:3072
    s_waitcnt lgkmcnt(2)
    v_pk_add_f32 v[74:75], v[74:75], v[42:43]
    v_pk_add_f32 v[76:77], v[76:77], v[44:45]
    v_pk_add_f32 v[78:79], v[78:79], v[46:47]
    v_pk_add_f32 v[80:81], v[80:81], v[48:49]
    v_cvt_pk_bf16_f32 v58, v74, v75
    v_cvt_pk_bf16_f32 v59, v76, v77
    v_cvt_pk_bf16_f32 v60, v78, v79
    v_cvt_pk_bf16_f32 v61, v80, v81
    s_waitcnt lgkmcnt(0)
    v_pk_add_f32 v[82:83], v[82:83], v[50:51]
    v_pk_add_f32 v[84:85], v[84:85], v[52:53]
    v_pk_add_f32 v[86:87], v[86:87], v[54:55]
    v_pk_add_f32 v[88:89], v[88:89], v[56:57]
    v_cvt_pk_bf16_f32 v62, v82, v83
    v_cvt_pk_bf16_f32 v63, v84, v85
    v_cvt_pk_bf16_f32 v64, v86, v87
    v_cvt_pk_bf16_f32 v65, v88, v89
    s_branch Lk2_40
Lk1_39:
    ds_write_b128 v2, v[74:77] offset:0
    ds_write_b128 v2, v[78:81] offset:1024
    ds_write_b128 v2, v[82:85] offset:2048
    ds_write_b128 v2, v[86:89] offset:3072
    s_waitcnt lgkmcnt(0)
    s_mov_b64 exec, 1
    ds_add_u32 v4, v4 offset:0
    s_mov_b64 exec, -1
Lw_42:
    ds_read_b32 v6, v4 offset:0
    s_waitcnt lgkmcnt(0)
    v_readfirstlane_b32 s63, v6
    s_nop 0
    s_cmp_lg_u32 s63, s18
    s_cbranch_scc1 Lw_42
    ds_read_b128 v[42:45], v3 offset:0
    ds_read_b128 v[46:49], v3 offset:1024
    ds_read_b128 v[50:53], v3 offset:2048
    ds_read_b128 v[54:57], v3 offset:3072
    s_waitcnt lgkmcnt(2)
    v_pk_add_f32 v[90:91], v[90:91], v[42:43]
    v_pk_add_f32 v[92:93], v[92:93], v[44:45]
    v_pk_add_f32 v[94:95], v[94:95], v[46:47]
    v_pk_add_f32 v[96:97], v[96:97], v[48:49]
    v_cvt_pk_bf16_f32 v58, v90, v91
    v_cvt_pk_bf16_f32 v59, v92, v93
    v_cvt_pk_bf16_f32 v60, v94, v95
    v_cvt_pk_bf16_f32 v61, v96, v97
    s_waitcnt lgkmcnt(0)
    v_pk_add_f32 v[98:99], v[98:99], v[50:51]
    v_pk_add_f32 v[100:101], v[100:101], v[52:53]
    v_pk_add_f32 v[102:103], v[102:103], v[54:55]
    v_pk_add_f32 v[104:105], v[104:105], v[56:57]
    v_cvt_pk_bf16_f32 v62, v98, v99
    v_cvt_pk_bf16_f32 v63, v100, v101
    v_cvt_pk_bf16_f32 v64, v102, v103
    v_cvt_pk_bf16_f32 v65, v104, v105
Lk2_40:
    s_mov_b64 exec, 1
    ds_add_u32 v9, v9 offset:28
    s_mov_b64 exec, -1
    v_permlane32_swap_b32 v58, v60
    v_permlane32_swap_b32 v59, v61
    v_permlane32_swap_b32 v62, v64
    v_permlane32_swap_b32 v63, v65
    v_permlane16_swap_b32 v58, v59
    v_permlane16_swap_b32 v60, v61
    buffer_store_dwordx4 v[58:61], v8, s[52:55], s15 offen offset:0 sc1
    v_permlane16_swap_b32 v62, v63
    v_permlane16_swap_b32 v64, v65
    buffer_store_dwordx4 v[62:65], v8, s[52:55], s15 offen offset:1024 sc1
    s_waitcnt vmcnt(0)
    s_mov_b64 exec, 1
    ds_add_rtn_u32 v6, v9, v9 offset:40
    s_waitcnt lgkmcnt(0)
    v_readfirstlane_b32 s63, v6
    s_nop 0
    s_cmp_lg_u32 s63, 479232
    s_cbranch_scc1 Lyl_43
    s_andn2_b32 s16, s16, 15
    buffer_store_dword v5, off, s[52:55], s16 sc1
Lyl_43:
    s_mov_b64 exec, -1
    s_setprio 0
    s_lshr_b32 s63, s5, 4
    s_lshl1_add_u32 s6, s4, s63
    s_and_b32 s7, s5, 15
    s_lshl_b32 s64, s7, 2
    s_mov_b32 s100, 0x87654210
    s_mov_b32 s101, 0xb3fedca9
    s_lshr_b64 s[100:101], s[100:101], s64
    s_and_b32 s56, s100, 7
    s_bfe_u32 s63, s100, 0x10003
    s_lshl1_add_u32 s63, s6, s63
    s_lshl_b32 s57, s63, 6
    v_lshlrev_b32 v8, 4, v1
    v_lshrrev_b32 v2, 3, v1
    v_and_b32 v3, 7, v1
    v_lshlrev_b32 v10, 4, v3
    v_lshl_add_u32 v10, v2, 12, v10
    s_lshl2_add_u32 s66, s56, s12
    s_lshl_b32 s67, s66, 16
    s_lshl1_add_u32 s67, s57, s67
    s_add_u32 s67, s67, 8388608
    s_add_u32 s68, s67, 32768
    s_lshl_b32 s66, s66, 10
    s_add_u32 s66, s66, 32768
    v_lshlrev_b32 v11, 7, v2
    v_lshlrev_b32 v4, 10, v3
    v_lshl_add_u32 v4, v2, 1, v4
    v_add_u32 v4, 98304, v4
    s_lshl_b32 s64, s12, 1
    v_xor_b32 v3, s64, v3
    v_xor_b32 v14, 0, v3
    v_lshl_add_u32 v14, v14, 4, v4
    v_xor_b32 v15, 1, v3
    v_lshl_add_u32 v15, v15, 4, v4
    s_setprio 3
    s_barrier
    s_barrier
    s_mov_b32 s64, 262144
Lpoll_45:
    buffer_load_dword v12, v11, s[52:55], s66 offen sc1
    s_waitcnt vmcnt(0)
    v_cmp_ne_u32 vcc, v12, v5
    s_nop 4
    s_cbranch_vccz Lyok_44
    s_sub_u32 s64, s64, 1
    s_cbranch_scc0 Lpoll_45
Lyok_44:
    buffer_load_dwordx4 v[16:19], v10, s[52:55], s67 offen sc1
    buffer_load_dwordx4 v[20:23], v10, s[52:55], s68 offen sc1
    s_waitcnt vmcnt(1)
    ds_write_b16 v14, v16 offset:0
    ds_write_b16_d16_hi v14, v16 offset:128
    ds_write_b16 v14, v17 offset:256
    ds_write_b16_d16_hi v14, v17 offset:384
    ds_write_b16 v14, v18 offset:512
    ds_write_b16_d16_hi v14, v18 offset:640
    ds_write_b16 v14, v19 offset:768
    ds_write_b16_d16_hi v14, v19 offset:896
    s_waitcnt vmcnt(0)
    ds_write_b16 v15, v20 offset:0
    ds_write_b16_d16_hi v15, v20 offset:128
    ds_write_b16 v15, v21 offset:256
    ds_write_b16_d16_hi v15, v21 offset:384
    ds_write_b16 v15, v22 offset:512
    ds_write_b16_d16_hi v15, v22 offset:640
    ds_write_b16 v15, v23 offset:768
    ds_write_b16_d16_hi v15, v23 offset:896
    s_waitcnt lgkmcnt(0)
    s_barrier
    s_endpgm
    .p2align 6
L_gemm:
    s_setprio 1
    s_sub_u32 s24, s3, 8
    s_and_b32 s25, s24, 3
    s_lshr_b32 s26, s24, 2
    s_lshr_b32 s63, s5, 4
    s_lshl1_add_u32 s6, s4, s63
    s_and_b32 s7, s5, 15
    s_lshl_b32 s64, s7, 2
    s_mov_b32 s100, 0x87654210
    s_mov_b32 s101, 0xb3fedca9
    s_lshr_b64 s[100:101], s[100:101], s64
    s_and_b32 s56, s100, 7
    s_bfe_u32 s63, s100, 0x10003
    s_lshl1_add_u32 s63, s6, s63
    s_lshl_b32 s57, s63, 6
    v_lshlrev_b32 v8, 4, v1
    s_mov_b32 s34, 2752
    s_mov_b32 s35, 0x20000
    s_mul_i32 s63, s7, 192
    s_mul_i32 s64, s26, 96
    s_add_u32 s63, s63, s64
    s_add_u32 s65, s63, 64
    s_waitcnt lgkmcnt(0)
    s_buffer_load_dwordx8 s[12:19], s[32:35], s63
    s_add_u32 s63, s63, 32
    s_buffer_load_dwordx4 s[20:23], s[32:35], s63
    s_add_u32 s63, s63, 16
    s_buffer_load_dwordx4 s[28:31], s[32:35], s63
    s_buffer_load_dwordx4 s[36:39], s[32:35], s65
    s_add_u32 s65, s65, 16
    s_buffer_load_dwordx4 s[44:47], s[32:35], s65
    s_load_dwordx2 s[40:41], s[0:1], 80
    s_load_dwordx2 s[52:53], s[0:1], 112
    s_load_dwordx2 s[48:49], s[0:1], 96
    s_mov_b32 s10, 2097152
    s_mov_b32 s11, 0x20000
    s_mov_b32 s54, 268435456
    s_mov_b32 s55, 0x20000
    s_mov_b32 s42, 1024
    s_mov_b32 s43, 0x20000
    s_mov_b32 s50, 2097152
    s_mov_b32 s51, 0x20000
    v_and_b32 v111, 15, v1
    v_lshrrev_b32 v109, 1, v111
    v_lshrrev_b32 v110, 4, v1
    v_xor_b32 v109, v109, v110
    v_lshlrev_b32 v109, 4, v109
    v_lshl_add_u32 v10, v111, 7, v109
    s_lshl_b32 s63, s25, 12
    v_add_u32 v10, s63, v10
    v_xor_b32 v11, 64, v10
    v_bfe_u32 v112, v1, 2, 2
    v_lshl_add_u32 v108, v110, 3, v112
    v_mul_u32_u24 v108, 192, v108
    v_and_b32 v113, 3, v1
    v_lshl_add_u32 v108, v113, 3, v108
    s_add_u32 s64, s64, 16384
    v_add_u32 v108, s64, v108
    v_and_b32 v109, 1, v110
    s_lshl_b32 s65, s26, 6
    s_sub_u32 s65, 32, s65
    v_mul_lo_u32 v109, v109, s65
    v_add_u32 v12, v108, v109
    v_sub_u32 v13, v108, v109
    v_add_u32 v14, 57344, v10
    v_add_u32 v15, 57344, v11
    v_add_u32 v122, 57344, v12
    v_add_u32 v123, 57344, v13
    v_mov_b32 v9, 159744
    v_lshl_add_u32 v2, v110, 3, v112
    v_lshlrev_b32 v2, 7, v2
    v_lshrrev_b32 v109, 1, v112
    v_lshl_add_u32 v2, v109, 6, v2
    v_and_b32 v109, 1, v110
    v_lshl_add_u32 v2, v109, 5, v2
    v_lshl_add_u32 v2, v113, 3, v2
    v_add_u32 v2, s63, v2
    v_lshlrev_b32 v4, 9, v110
    v_lshl_add_u32 v4, v111, 4, v4
    v_bfe_u32 v108, v0, 3, 6
    v_and_b32 v109, 7, v0
    v_lshlrev_b32 v110, 4, v109
    v_lshl_add_u32 v3, v108, 10, v110
    v_lshlrev_b32 v7, 3, v108
    v_and_b32 v111, 1, v1
    v_lshlrev_b32 v5, 5, v111
    v_bfe_u32 v111, v1, 1, 1
    v_mul_u32_u24 v111, 2112, v111
    v_add_u32 v5, v5, v111
    v_bfe_u32 v111, v1, 2, 1
    v_mul_u32_u24 v111, 256, v111
    v_add_u32 v5, v5, v111
    v_bfe_u32 v111, v1, 3, 1
    v_mul_u32_u24 v111, 1040, v111
    v_add_u32 v5, v5, v111
    v_bfe_u32 v111, v1, 4, 1
    v_mul_u32_u24 v111, 4224, v111
    v_add_u32 v5, v5, v111
    v_bfe_u32 v111, v1, 5, 1
    v_mul_u32_u24 v111, 64, v111
    v_add_u32 v5, v5, v111
    s_mul_i32 s63, s26, 8448
    s_and_b32 s64, s25, 1
    s_lshl_b32 s64, s64, 7
    s_lshr_b32 s65, s25, 1
    s_lshl_b32 s65, s65, 9
    s_add_u32 s64, s64, s65
    s_add_u32 s64, s64, s63
    v_add_u32 v5, s64, v5
    s_mul_i32 s64, s25, 16896
    s_add_u32 m0, s63, s64
    v_xor_b32 v6, s24, v109
    v_lshlrev_b32 v6, 4, v6
    v_lshl_add_u32 v6, v108, 7, v6
    v_add_u32 v6, 98304, v6
    s_lshl_b32 s27, s57, 3
    s_add_u32 s27, s27, 16384
    s_lshl_b32 s67, s57, 10
    s_lshl_b32 s68, s56, 7
    s_add_u32 s67, s67, s68
    s_waitcnt lgkmcnt(0)
    s_load_dword s58, s[52:53], 4096
    s_load_dword s96, s[52:53], 131072
    buffer_load_dwordx4 v[16:19], v110, s[40:43], s68 offen
    v_mov_b32 v114, s12
    v_mov_b32 v115, s13
    v_mov_b32 v116, s20
    v_mov_b32 v117, s21
    v_mov_b32 v118, s36
    v_mov_b32 v119, s37
    s_mov_b32 exec_lo, 0xffff0000
    v_mov_b32 v114, s14
    v_mov_b32 v115, s15
    v_mov_b32 v116, s22
    v_mov_b32 v117, s23
    v_mov_b32 v118, s38
    v_mov_b32 v119, s39
    s_mov_b32 exec_lo, 0
    v_mov_b32 v114, s16
    v_mov_b32 v115, s17
    v_mov_b32 v116, s28
    v_mov_b32 v117, s29
    v_mov_b32 v118, s44
    v_mov_b32 v119, s45
    s_mov_b32 exec_hi, 0xffff0000
    v_mov_b32 v114, s18
    v_mov_b32 v115, s19
    v_mov_b32 v116, s30
    v_mov_b32 v117, s31
    v_mov_b32 v118, s46
    v_mov_b32 v119, s47
    s_mov_b64 exec, -1
    v_lshlrev_b32 v64, 16, v114
    v_and_b32 v65, 0xffff0000, v114
    v_lshlrev_b32 v66, 16, v115
    v_and_b32 v67, 0xffff0000, v115
    v_lshlrev_b32 v68, 16, v116
    v_and_b32 v69, 0xffff0000, v116
    v_lshlrev_b32 v70, 16, v117
    v_and_b32 v71, 0xffff0000, v117
    v_lshlrev_b32 v72, 16, v118
    v_and_b32 v73, 0xffff0000, v118
    v_lshlrev_b32 v74, 16, v119
    v_and_b32 v75, 0xffff0000, v119
    s_lshr_b32 s66, s57, 5
    s_add_u32 s66, s66, s26
    s_mul_i32 s66, s66, 86
    s_lshl1_add_u32 s66, s25, s66
    s_lshl_b32 s66, s66, 10
    s_add_u32 s12, s66, 196608
    s_add_u32 s13, s12, 81920
    s_mov_b32 s63, s4
    s_sub_u32 s64, s63, 10
    s_cmp_ge_u32 s63, 10
    s_cselect_b32 s63, s64, s63
    s_sub_u32 s64, s63, 10
    s_cmp_ge_u32 s63, 10
    s_cselect_b32 s63, s64, s63
    s_lshl_b32 s64, s63, 13
    s_add_u32 s15, s64, s12
    s_brev_b32 s17, 2
    s_cmp_eq_u32 s25, 3
    s_cselect_b32 s14, s17, s13
    s_lshl2_add_u32 s63, s6, s25
    s_mul_i32 s63, s63, 86
    s_mul_i32 s64, s7, 6
    s_mul_i32 s65, s26, 3
    s_add_u32 s64, s64, s65
    s_add_u32 s63, s63, s64
    s_lshl_b32 s63, s63, 10
    s_add_u32 s63, s63, 196608
    s_cmp_lt_u32 s64, 86
    s_cselect_b32 s28, s63, s17
    s_cmp_lt_u32 s64, 85
    s_cselect_b32 s29, s63, s17
    s_cmp_lt_u32 s64, 84
    s_cselect_b32 s30, s63, s17
    s_mov_b32 s46, 0xbdd2d3e8
    s_mov_b32 s47, 0xc0135761
    s_lshl_b32 s18, s6, 12
    s_lshl2_add_u32 s18, s7, s18
    s_add_u32 s18, s18, 65536
    s_lshl_b32 s19, s6, 7
    s_lshl2_add_u32 s19, s7, s19
    s_add_u32 s19, s19, 10240
    s_waitcnt lgkmcnt(0)
    s_add_u32 s58, s58, s96
    s_add_u32 s58, s58, 2654435761
    s_cmp_eq_u32 s7, 15
    s_cbranch_scc1 L_gwg
    s_barrier
    ds_read_b128 v[24:27], v10 offset:0
    ds_read_b128 v[28:31], v10 offset:2048
    ds_read_b64_tr_b16 v[32:33], v12 offset:0
    ds_read_b64_tr_b16 v[34:35], v12 offset:768
    ds_read_b64_tr_b16 v[36:37], v13 offset:32
    ds_read_b64_tr_b16 v[38:39], v13 offset:800
    ds_read_b64_tr_b16 v[40:41], v12 offset:64
    ds_read_b64_tr_b16 v[42:43], v12 offset:832
    ds_read_b128 v[44:47], v11 offset:0
    ds_read_b128 v[48:51], v11 offset:2048
    ds_read_b64_tr_b16 v[52:53], v12 offset:6144
    ds_read_b64_tr_b16 v[54:55], v12 offset:6912
    ds_read_b64_tr_b16 v[56:57], v13 offset:6176
    ds_read_b64_tr_b16 v[58:59], v13 offset:6944
    ds_read_b64_tr_b16 v[60:61], v12 offset:6208
    ds_read_b64_tr_b16 v[62:63], v12 offset:6976
    s_waitcnt lgkmcnt(12)
    v_mfma_f32_16x16x32_bf16 v[84:87], v[32:35], v[24:27], v[64:67]
    v_mfma_f32_16x16x32_bf16 v[88:91], v[32:35], v[28:31], v[64:67]
    s_waitcnt lgkmcnt(10)
    v_mfma_f32_16x16x32_bf16 v[92:95], v[36:39], v[24:27], v[68:71]
    v_mfma_f32_16x16x32_bf16 v[96:99], v[36:39], v[28:31], v[68:71]
    s_waitcnt lgkmcnt(8)
    v_mfma_f32_16x16x32_bf16 v[100:103], v[40:43], v[24:27], v[72:75]
    v_mfma_f32_16x16x32_bf16 v[104:107], v[40:43], v[28:31], v[72:75]
    s_waitcnt lgkmcnt(0)
    s_barrier
    ds_read_b128 v[24:27], v10 offset:28672
    ds_read_b128 v[28:31], v10 offset:30720
    ds_read_b64_tr_b16 v[32:33], v12 offset:28672
    ds_read_b64_tr_b16 v[34:35], v12 offset:29440
    ds_read_b64_tr_b16 v[36:37], v13 offset:28704
    ds_read_b64_tr_b16 v[38:39], v13 offset:29472
    ds_read_b64_tr_b16 v[40:41], v12 offset:28736
    ds_read_b64_tr_b16 v[42:43], v12 offset:29504
    ds_read_b128 v[64:67], v11 offset:28672
    ds_read_b128 v[68:71], v11 offset:30720
    ds_read_b64_tr_b16 v[72:73], v12 offset:34816
    ds_read_b64_tr_b16 v[74:75], v12 offset:35584
    ds_read_b64_tr_b16 v[76:77], v13 offset:34848
    ds_read_b64_tr_b16 v[78:79], v13 offset:35616
    ds_read_b64_tr_b16 v[80:81], v12 offset:34880
    ds_read_b64_tr_b16 v[82:83], v12 offset:35648
    v_mfma_f32_16x16x32_bf16 v[84:87], v[52:55], v[44:47], v[84:87]
    v_mfma_f32_16x16x32_bf16 v[88:91], v[52:55], v[48:51], v[88:91]
    v_mfma_f32_16x16x32_bf16 v[92:95], v[56:59], v[44:47], v[92:95]
    v_mfma_f32_16x16x32_bf16 v[96:99], v[56:59], v[48:51], v[96:99]
    v_mfma_f32_16x16x32_bf16 v[100:103], v[60:63], v[44:47], v[100:103]
    v_mfma_f32_16x16x32_bf16 v[104:107], v[60:63], v[48:51], v[104:107]
    s_waitcnt lgkmcnt(12)
    v_mfma_f32_16x16x32_bf16 v[84:87], v[32:35], v[24:27], v[84:87]
    v_mfma_f32_16x16x32_bf16 v[88:91], v[32:35], v[28:31], v[88:91]
    s_waitcnt lgkmcnt(10)
    v_mfma_f32_16x16x32_bf16 v[92:95], v[36:39], v[24:27], v[92:95]
    v_mfma_f32_16x16x32_bf16 v[96:99], v[36:39], v[28:31], v[96:99]
    s_waitcnt lgkmcnt(8)
    v_mfma_f32_16x16x32_bf16 v[100:103], v[40:43], v[24:27], v[100:103]
    v_mfma_f32_16x16x32_bf16 v[104:107], v[40:43], v[28:31], v[104:107]
    s_waitcnt lgkmcnt(0)
    s_barrier
    ds_read_b128 v[24:27], v14 offset:0
    ds_read_b128 v[28:31], v14 offset:2048
    ds_read_b64_tr_b16 v[32:33], v122 offset:0
    ds_read_b64_tr_b16 v[34:35], v122 offset:768
    ds_read_b64_tr_b16 v[36:37], v123 offset:32
    ds_read_b64_tr_b16 v[38:39], v123 offset:800
    ds_read_b64_tr_b16 v[40:41], v122 offset:64
    ds_read_b64_tr_b16 v[42:43], v122 offset:832
    ds_read_b128 v[44:47], v15 offset:0
    ds_read_b128 v[48:51], v15 offset:2048
    ds_read_b64_tr_b16 v[52:53], v122 offset:6144
    ds_read_b64_tr_b16 v[54:55], v122 offset:6912
    ds_read_b64_tr_b16 v[56:57], v123 offset:6176
    ds_read_b64_tr_b16 v[58:59], v123 offset:6944
    ds_read_b64_tr_b16 v[60:61], v122 offset:6208
    ds_read_b64_tr_b16 v[62:63], v122 offset:6976
    v_mfma_f32_16x16x32_bf16 v[84:87], v[72:75], v[64:67], v[84:87]
    v_mfma_f32_16x16x32_bf16 v[88:91], v[72:75], v[68:71], v[88:91]
    v_mfma_f32_16x16x32_bf16 v[92:95], v[76:79], v[64:67], v[92:95]
    v_mfma_f32_16x16x32_bf16 v[96:99], v[76:79], v[68:71], v[96:99]
    v_mfma_f32_16x16x32_bf16 v[100:103], v[80:83], v[64:67], v[100:103]
    v_mfma_f32_16x16x32_bf16 v[104:107], v[80:83], v[68:71], v[104:107]
    s_waitcnt lgkmcnt(12)
    v_mfma_f32_16x16x32_bf16 v[84:87], v[32:35], v[24:27], v[84:87]
    v_mfma_f32_16x16x32_bf16 v[88:91], v[32:35], v[28:31], v[88:91]
    s_waitcnt lgkmcnt(10)
    v_mfma_f32_16x16x32_bf16 v[92:95], v[36:39], v[24:27], v[92:95]
    v_mfma_f32_16x16x32_bf16 v[96:99], v[36:39], v[28:31], v[96:99]
    s_waitcnt lgkmcnt(8)
    v_mfma_f32_16x16x32_bf16 v[100:103], v[40:43], v[24:27], v[100:103]
    v_mfma_f32_16x16x32_bf16 v[104:107], v[40:43], v[28:31], v[104:107]
    s_waitcnt lgkmcnt(0)
    s_barrier
    ds_read_b128 v[24:27], v14 offset:28672
    ds_read_b128 v[28:31], v14 offset:30720
    ds_read_b64_tr_b16 v[32:33], v122 offset:28672
    ds_read_b64_tr_b16 v[34:35], v122 offset:29440
    ds_read_b64_tr_b16 v[36:37], v123 offset:28704
    ds_read_b64_tr_b16 v[38:39], v123 offset:29472
    ds_read_b64_tr_b16 v[40:41], v122 offset:28736
    ds_read_b64_tr_b16 v[42:43], v122 offset:29504
    ds_read_b128 v[64:67], v15 offset:28672
    ds_read_b128 v[68:71], v15 offset:30720
    ds_read_b64_tr_b16 v[72:73], v122 offset:34816
    ds_read_b64_tr_b16 v[74:75], v122 offset:35584
    ds_read_b64_tr_b16 v[76:77], v123 offset:34848
    ds_read_b64_tr_b16 v[78:79], v123 offset:35616
    ds_read_b64_tr_b16 v[80:81], v122 offset:34880
    ds_read_b64_tr_b16 v[82:83], v122 offset:35648
    v_mfma_f32_16x16x32_bf16 v[84:87], v[52:55], v[44:47], v[84:87]
    v_mfma_f32_16x16x32_bf16 v[88:91], v[52:55], v[48:51], v[88:91]
    v_mfma_f32_16x16x32_bf16 v[92:95], v[56:59], v[44:47], v[92:95]
    v_mfma_f32_16x16x32_bf16 v[96:99], v[56:59], v[48:51], v[96:99]
    v_mfma_f32_16x16x32_bf16 v[100:103], v[60:63], v[44:47], v[100:103]
    v_mfma_f32_16x16x32_bf16 v[104:107], v[60:63], v[48:51], v[104:107]
    s_waitcnt lgkmcnt(12)
    v_mfma_f32_16x16x32_bf16 v[84:87], v[32:35], v[24:27], v[84:87]
    v_mfma_f32_16x16x32_bf16 v[88:91], v[32:35], v[28:31], v[88:91]
    s_waitcnt lgkmcnt(10)
    v_mfma_f32_16x16x32_bf16 v[92:95], v[36:39], v[24:27], v[92:95]
    v_mfma_f32_16x16x32_bf16 v[96:99], v[36:39], v[28:31], v[96:99]
    s_waitcnt lgkmcnt(8)
    v_mfma_f32_16x16x32_bf16 v[100:103], v[40:43], v[24:27], v[100:103]
    v_mfma_f32_16x16x32_bf16 v[104:107], v[40:43], v[28:31], v[104:107]
    s_waitcnt lgkmcnt(0)
    s_barrier
    ds_read_b128 v[24:27], v10 offset:0
    ds_read_b128 v[28:31], v10 offset:2048
    ds_read_b64_tr_b16 v[32:33], v12 offset:0
    ds_read_b64_tr_b16 v[34:35], v12 offset:768
    ds_read_b64_tr_b16 v[36:37], v13 offset:32
    ds_read_b64_tr_b16 v[38:39], v13 offset:800
    ds_read_b64_tr_b16 v[40:41], v12 offset:64
    ds_read_b64_tr_b16 v[42:43], v12 offset:832
    ds_read_b128 v[44:47], v11 offset:0
    ds_read_b128 v[48:51], v11 offset:2048
    ds_read_b64_tr_b16 v[52:53], v12 offset:6144
    ds_read_b64_tr_b16 v[54:55], v12 offset:6912
    ds_read_b64_tr_b16 v[56:57], v13 offset:6176
    ds_read_b64_tr_b16 v[58:59], v13 offset:6944
    ds_read_b64_tr_b16 v[60:61], v12 offset:6208
    ds_read_b64_tr_b16 v[62:63], v12 offset:6976
    v_mfma_f32_16x16x32_bf16 v[84:87], v[72:75], v[64:67], v[84:87]
    v_mfma_f32_16x16x32_bf16 v[88:91], v[72:75], v[68:71], v[88:91]
    v_mfma_f32_16x16x32_bf16 v[92:95], v[76:79], v[64:67], v[92:95]
    v_mfma_f32_16x16x32_bf16 v[96:99], v[76:79], v[68:71], v[96:99]
    v_mfma_f32_16x16x32_bf16 v[100:103], v[80:83], v[64:67], v[100:103]
    v_mfma_f32_16x16x32_bf16 v[104:107], v[80:83], v[68:71], v[104:107]
    s_waitcnt lgkmcnt(12)
    v_mfma_f32_16x16x32_bf16 v[84:87], v[32:35], v[24:27], v[84:87]
    v_mfma_f32_16x16x32_bf16 v[88:91], v[32:35], v[28:31], v[88:91]
    s_waitcnt lgkmcnt(10)
    v_mfma_f32_16x16x32_bf16 v[92:95], v[36:39], v[24:27], v[92:95]
    v_mfma_f32_16x16x32_bf16 v[96:99], v[36:39], v[28:31], v[96:99]
    s_waitcnt lgkmcnt(8)
    v_mfma_f32_16x16x32_bf16 v[100:103], v[40:43], v[24:27], v[100:103]
    v_mfma_f32_16x16x32_bf16 v[104:107], v[40:43], v[28:31], v[104:107]
    s_waitcnt lgkmcnt(0)
    s_barrier
    ds_read_b128 v[24:27], v10 offset:28672
    ds_read_b128 v[28:31], v10 offset:30720
    ds_read_b64_tr_b16 v[32:33], v12 offset:28672
    ds_read_b64_tr_b16 v[34:35], v12 offset:29440
    ds_read_b64_tr_b16 v[36:37], v13 offset:28704
    ds_read_b64_tr_b16 v[38:39], v13 offset:29472
    ds_read_b64_tr_b16 v[40:41], v12 offset:28736
    ds_read_b64_tr_b16 v[42:43], v12 offset:29504
    ds_read_b128 v[64:67], v11 offset:28672
    ds_read_b128 v[68:71], v11 offset:30720
    ds_read_b64_tr_b16 v[72:73], v12 offset:34816
    ds_read_b64_tr_b16 v[74:75], v12 offset:35584
    ds_read_b64_tr_b16 v[76:77], v13 offset:34848
    ds_read_b64_tr_b16 v[78:79], v13 offset:35616
    ds_read_b64_tr_b16 v[80:81], v12 offset:34880
    ds_read_b64_tr_b16 v[82:83], v12 offset:35648
    v_mfma_f32_16x16x32_bf16 v[84:87], v[52:55], v[44:47], v[84:87]
    v_mfma_f32_16x16x32_bf16 v[88:91], v[52:55], v[48:51], v[88:91]
    v_mfma_f32_16x16x32_bf16 v[92:95], v[56:59], v[44:47], v[92:95]
    v_mfma_f32_16x16x32_bf16 v[96:99], v[56:59], v[48:51], v[96:99]
    v_mfma_f32_16x16x32_bf16 v[100:103], v[60:63], v[44:47], v[100:103]
    v_mfma_f32_16x16x32_bf16 v[104:107], v[60:63], v[48:51], v[104:107]
    s_waitcnt lgkmcnt(12)
    v_mfma_f32_16x16x32_bf16 v[84:87], v[32:35], v[24:27], v[84:87]
    v_mfma_f32_16x16x32_bf16 v[88:91], v[32:35], v[28:31], v[88:91]
    s_waitcnt lgkmcnt(10)
    v_mfma_f32_16x16x32_bf16 v[92:95], v[36:39], v[24:27], v[92:95]
    v_mfma_f32_16x16x32_bf16 v[96:99], v[36:39], v[28:31], v[96:99]
    s_waitcnt lgkmcnt(8)
    v_mfma_f32_16x16x32_bf16 v[100:103], v[40:43], v[24:27], v[100:103]
    v_mfma_f32_16x16x32_bf16 v[104:107], v[40:43], v[28:31], v[104:107]
    s_waitcnt lgkmcnt(0)
    s_barrier
    ds_read_b128 v[24:27], v14 offset:0
    ds_read_b128 v[28:31], v14 offset:2048
    ds_read_b64_tr_b16 v[32:33], v122 offset:0
    ds_read_b64_tr_b16 v[34:35], v122 offset:768
    ds_read_b64_tr_b16 v[36:37], v123 offset:32
    ds_read_b64_tr_b16 v[38:39], v123 offset:800
    ds_read_b64_tr_b16 v[40:41], v122 offset:64
    ds_read_b64_tr_b16 v[42:43], v122 offset:832
    ds_read_b128 v[44:47], v15 offset:0
    ds_read_b128 v[48:51], v15 offset:2048
    ds_read_b64_tr_b16 v[52:53], v122 offset:6144
    ds_read_b64_tr_b16 v[54:55], v122 offset:6912
    ds_read_b64_tr_b16 v[56:57], v123 offset:6176
    ds_read_b64_tr_b16 v[58:59], v123 offset:6944
    ds_read_b64_tr_b16 v[60:61], v122 offset:6208
    ds_read_b64_tr_b16 v[62:63], v122 offset:6976
    v_mfma_f32_16x16x32_bf16 v[84:87], v[72:75], v[64:67], v[84:87]
    v_mfma_f32_16x16x32_bf16 v[88:91], v[72:75], v[68:71], v[88:91]
    v_mfma_f32_16x16x32_bf16 v[92:95], v[76:79], v[64:67], v[92:95]
    v_mfma_f32_16x16x32_bf16 v[96:99], v[76:79], v[68:71], v[96:99]
    v_mfma_f32_16x16x32_bf16 v[100:103], v[80:83], v[64:67], v[100:103]
    v_mfma_f32_16x16x32_bf16 v[104:107], v[80:83], v[68:71], v[104:107]
    s_waitcnt lgkmcnt(12)
    v_mfma_f32_16x16x32_bf16 v[84:87], v[32:35], v[24:27], v[84:87]
    v_mfma_f32_16x16x32_bf16 v[88:91], v[32:35], v[28:31], v[88:91]
    s_waitcnt lgkmcnt(10)
    v_mfma_f32_16x16x32_bf16 v[92:95], v[36:39], v[24:27], v[92:95]
    v_mfma_f32_16x16x32_bf16 v[96:99], v[36:39], v[28:31], v[96:99]
    s_waitcnt lgkmcnt(8)
    v_mfma_f32_16x16x32_bf16 v[100:103], v[40:43], v[24:27], v[100:103]
    v_mfma_f32_16x16x32_bf16 v[104:107], v[40:43], v[28:31], v[104:107]
    s_waitcnt lgkmcnt(0)
    s_barrier
    ds_read_b128 v[24:27], v14 offset:28672
    ds_read_b128 v[28:31], v14 offset:30720
    ds_read_b64_tr_b16 v[32:33], v122 offset:28672
    ds_read_b64_tr_b16 v[34:35], v122 offset:29440
    ds_read_b64_tr_b16 v[36:37], v123 offset:28704
    ds_read_b64_tr_b16 v[38:39], v123 offset:29472
    ds_read_b64_tr_b16 v[40:41], v122 offset:28736
    ds_read_b64_tr_b16 v[42:43], v122 offset:29504
    ds_read_b128 v[64:67], v15 offset:28672
    ds_read_b128 v[68:71], v15 offset:30720
    ds_read_b64_tr_b16 v[72:73], v122 offset:34816
    ds_read_b64_tr_b16 v[74:75], v122 offset:35584
    ds_read_b64_tr_b16 v[76:77], v123 offset:34848
    ds_read_b64_tr_b16 v[78:79], v123 offset:35616
    ds_read_b64_tr_b16 v[80:81], v122 offset:34880
    ds_read_b64_tr_b16 v[82:83], v122 offset:35648
    v_mfma_f32_16x16x32_bf16 v[84:87], v[52:55], v[44:47], v[84:87]
    v_mfma_f32_16x16x32_bf16 v[88:91], v[52:55], v[48:51], v[88:91]
    v_mfma_f32_16x16x32_bf16 v[92:95], v[56:59], v[44:47], v[92:95]
    v_mfma_f32_16x16x32_bf16 v[96:99], v[56:59], v[48:51], v[96:99]
    v_mfma_f32_16x16x32_bf16 v[100:103], v[60:63], v[44:47], v[100:103]
    v_mfma_f32_16x16x32_bf16 v[104:107], v[60:63], v[48:51], v[104:107]
    s_waitcnt lgkmcnt(12)
    v_mfma_f32_16x16x32_bf16 v[84:87], v[32:35], v[24:27], v[84:87]
    v_mfma_f32_16x16x32_bf16 v[88:91], v[32:35], v[28:31], v[88:91]
    s_waitcnt lgkmcnt(10)
    v_mfma_f32_16x16x32_bf16 v[92:95], v[36:39], v[24:27], v[92:95]
    v_mfma_f32_16x16x32_bf16 v[96:99], v[36:39], v[28:31], v[96:99]
    s_waitcnt lgkmcnt(8)
    v_mfma_f32_16x16x32_bf16 v[100:103], v[40:43], v[24:27], v[100:103]
    v_mfma_f32_16x16x32_bf16 v[104:107], v[40:43], v[28:31], v[104:107]
    s_waitcnt lgkmcnt(0)
    s_barrier
    v_mfma_f32_16x16x32_bf16 v[84:87], v[72:75], v[64:67], v[84:87]
    v_mfma_f32_16x16x32_bf16 v[88:91], v[72:75], v[68:71], v[88:91]
    v_mfma_f32_16x16x32_bf16 v[92:95], v[76:79], v[64:67], v[92:95]
    v_mfma_f32_16x16x32_bf16 v[96:99], v[76:79], v[68:71], v[96:99]
    v_mfma_f32_16x16x32_bf16 v[100:103], v[80:83], v[64:67], v[100:103]
    v_mfma_f32_16x16x32_bf16 v[104:107], v[80:83], v[68:71], v[104:107]
    s_nop 2
    v_pk_mul_f32 v[24:25], v[84:85], v[84:85]
    v_pk_mul_f32 v[26:27], v[86:87], v[86:87]
    v_pk_mul_f32 v[28:29], v[88:89], v[88:89]
    v_pk_mul_f32 v[30:31], v[90:91], v[90:91]
    v_pk_fma_f32 v[24:25], v[24:25], s[46:47], s[46:47] op_sel:[0,0,1] op_sel_hi:[1,0,1]
    v_pk_fma_f32 v[26:27], v[26:27], s[46:47], s[46:47] op_sel:[0,0,1] op_sel_hi:[1,0,1]
    v_pk_fma_f32 v[28:29], v[28:29], s[46:47], s[46:47] op_sel:[0,0,1] op_sel_hi:[1,0,1]
    v_pk_fma_f32 v[30:31], v[30:31], s[46:47], s[46:47] op_sel:[0,0,1] op_sel_hi:[1,0,1]
    v_pk_mul_f32 v[24:25], v[24:25], v[84:85]
    v_pk_mul_f32 v[26:27], v[26:27], v[86:87]
    v_pk_mul_f32 v[28:29], v[28:29], v[88:89]
    v_pk_mul_f32 v[30:31], v[30:31], v[90:91]
    v_exp_f32 v24, v24
    v_exp_f32 v25, v25
    v_exp_f32 v26, v26
    v_exp_f32 v27, v27
    v_exp_f32 v28, v28
    v_exp_f32 v29, v29
    v_exp_f32 v30, v30
    v_exp_f32 v31, v31
    v_pk_add_f32 v[24:25], v[24:25], 1.0 op_sel_hi:[1,0]
    v_pk_add_f32 v[26:27], v[26:27], 1.0 op_sel_hi:[1,0]
    v_pk_add_f32 v[28:29], v[28:29], 1.0 op_sel_hi:[1,0]
    v_pk_add_f32 v[30:31], v[30:31], 1.0 op_sel_hi:[1,0]
    v_rcp_f32 v24, v24
    v_rcp_f32 v25, v25
    v_rcp_f32 v26, v26
    v_rcp_f32 v27, v27
    v_rcp_f32 v28, v28
    v_rcp_f32 v29, v29
    v_rcp_f32 v30, v30
    v_rcp_f32 v31, v31
    v_pk_mul_f32 v[24:25], v[24:25], v[84:85]
    v_pk_mul_f32 v[26:27], v[26:27], v[86:87]
    v_pk_mul_f32 v[28:29], v[28:29], v[88:89]
    v_pk_mul_f32 v[30:31], v[30:31], v[90:91]
    v_cvt_pk_bf16_f32 v48, v24, v25
    v_cvt_pk_bf16_f32 v50, v28, v29
    v_cvt_pk_bf16_f32 v49, v26, v27
    v_cvt_pk_bf16_f32 v51, v30, v31
    v_permlane16_swap_b32 v48, v50
    s_nop 0
    v_permlane16_swap_b32 v49, v51
    buffer_store_dwordx4 v[48:51], v8, s[52:55], s28 offen offset:0 sc1
    v_pk_mul_f32 v[32:33], v[92:93], v[92:93]
    v_pk_mul_f32 v[34:35], v[94:95], v[94:95]
    v_pk_mul_f32 v[36:37], v[96:97], v[96:97]
    v_pk_mul_f32 v[38:39], v[98:99], v[98:99]
    v_pk_fma_f32 v[32:33], v[32:33], s[46:47], s[46:47] op_sel:[0,0,1] op_sel_hi:[1,0,1]
    v_pk_fma_f32 v[34:35], v[34:35], s[46:47], s[46:47] op_sel:[0,0,1] op_sel_hi:[1,0,1]
    v_pk_fma_f32 v[36:37], v[36:37], s[46:47], s[46:47] op_sel:[0,0,1] op_sel_hi:[1,0,1]
    v_pk_fma_f32 v[38:39], v[38:39], s[46:47], s[46:47] op_sel:[0,0,1] op_sel_hi:[1,0,1]
    v_pk_mul_f32 v[32:33], v[32:33], v[92:93]
    v_pk_mul_f32 v[34:35], v[34:35], v[94:95]
    v_pk_mul_f32 v[36:37], v[36:37], v[96:97]
    v_pk_mul_f32 v[38:39], v[38:39], v[98:99]
    v_exp_f32 v32, v32
    v_exp_f32 v33, v33
    v_exp_f32 v34, v34
    v_exp_f32 v35, v35
    v_exp_f32 v36, v36
    v_exp_f32 v37, v37
    v_exp_f32 v38, v38
    v_exp_f32 v39, v39
    v_pk_add_f32 v[32:33], v[32:33], 1.0 op_sel_hi:[1,0]
    v_pk_add_f32 v[34:35], v[34:35], 1.0 op_sel_hi:[1,0]
    v_pk_add_f32 v[36:37], v[36:37], 1.0 op_sel_hi:[1,0]
    v_pk_add_f32 v[38:39], v[38:39], 1.0 op_sel_hi:[1,0]
    v_rcp_f32 v32, v32
    v_rcp_f32 v33, v33
    v_rcp_f32 v34, v34
    v_rcp_f32 v35, v35
    v_rcp_f32 v36, v36
    v_rcp_f32 v37, v37
    v_rcp_f32 v38, v38
    v_rcp_f32 v39, v39
    v_pk_mul_f32 v[32:33], v[32:33], v[92:93]
    v_pk_mul_f32 v[34:35], v[34:35], v[94:95]
    v_pk_mul_f32 v[36:37], v[36:37], v[96:97]
    v_pk_mul_f32 v[38:39], v[38:39], v[98:99]
    v_cvt_pk_bf16_f32 v52, v32, v33
    v_cvt_pk_bf16_f32 v54, v36, v37
    v_cvt_pk_bf16_f32 v53, v34, v35
    v_cvt_pk_bf16_f32 v55, v38, v39
    v_permlane16_swap_b32 v52, v54
    s_nop 0
    v_permlane16_swap_b32 v53, v55
    buffer_store_dwordx4 v[52:55], v8, s[52:55], s29 offen offset:1024 sc1
    v_pk_mul_f32 v[40:41], v[100:101], v[100:101]
    v_pk_mul_f32 v[42:43], v[102:103], v[102:103]
    v_pk_mul_f32 v[44:45], v[104:105], v[104:105]
    v_pk_mul_f32 v[46:47], v[106:107], v[106:107]
    v_pk_fma_f32 v[40:41], v[40:41], s[46:47], s[46:47] op_sel:[0,0,1] op_sel_hi:[1,0,1]
    v_pk_fma_f32 v[42:43], v[42:43], s[46:47], s[46:47] op_sel:[0,0,1] op_sel_hi:[1,0,1]
    v_pk_fma_f32 v[44:45], v[44:45], s[46:47], s[46:47] op_sel:[0,0,1] op_sel_hi:[1,0,1]
    v_pk_fma_f32 v[46:47], v[46:47], s[46:47], s[46:47] op_sel:[0,0,1] op_sel_hi:[1,0,1]
    v_pk_mul_f32 v[40:41], v[40:41], v[100:101]
    v_pk_mul_f32 v[42:43], v[42:43], v[102:103]
    v_pk_mul_f32 v[44:45], v[44:45], v[104:105]
    v_pk_mul_f32 v[46:47], v[46:47], v[106:107]
    v_exp_f32 v40, v40
    v_exp_f32 v41, v41
    v_exp_f32 v42, v42
    v_exp_f32 v43, v43
    v_exp_f32 v44, v44
    v_exp_f32 v45, v45
    v_exp_f32 v46, v46
    v_exp_f32 v47, v47
    v_pk_add_f32 v[40:41], v[40:41], 1.0 op_sel_hi:[1,0]
    v_pk_add_f32 v[42:43], v[42:43], 1.0 op_sel_hi:[1,0]
    v_pk_add_f32 v[44:45], v[44:45], 1.0 op_sel_hi:[1,0]
    v_pk_add_f32 v[46:47], v[46:47], 1.0 op_sel_hi:[1,0]
    v_rcp_f32 v40, v40
    v_rcp_f32 v41, v41
    v_rcp_f32 v42, v42
    v_rcp_f32 v43, v43
    v_rcp_f32 v44, v44
    v_rcp_f32 v45, v45
    v_rcp_f32 v46, v46
    v_rcp_f32 v47, v47
    v_pk_mul_f32 v[40:41], v[40:41], v[100:101]
    v_pk_mul_f32 v[42:43], v[42:43], v[102:103]
    v_pk_mul_f32 v[44:45], v[44:45], v[104:105]
    v_pk_mul_f32 v[46:47], v[46:47], v[106:107]
    s_mov_b64 exec, 1
    ds_add_u32 v9, v9 offset:8
    s_mov_b64 exec, -1
    v_cvt_pk_bf16_f32 v56, v40, v41
    v_cvt_pk_bf16_f32 v58, v44, v45
    v_cvt_pk_bf16_f32 v57, v42, v43
    v_cvt_pk_bf16_f32 v59, v46, v47
    v_permlane16_swap_b32 v56, v58
    s_nop 0
    v_permlane16_swap_b32 v57, v59
    buffer_store_dwordx4 v[56:59], v8, s[52:55], s30 offen offset:2048 sc1
L_join:
    v_lshlrev_b32 v25, 3, v8
    v_xor_b32 v10, 32, v2
    v_xor_b32 v11, 64, v2
    v_xor_b32 v12, 96, v2
    v_add_u32 v13, 65536, v2
    v_add_u32 v14, 65536, v10
    v_add_u32 v15, 65536, v11
    v_add_u32 v8, 65536, v12
    v_mov_b32 v24, s58
    s_waitcnt vmcnt(0)
    s_mov_b64 exec, 1
    ds_add_rtn_u32 v60, v9, v9
    s_mov_b64 exec, -1
    s_waitcnt lgkmcnt(0)
    v_readfirstlane_b32 s63, v60
    s_nop 0
    s_cmp_lg_u32 s63, 1437696
    s_cbranch_scc1 Lnl_46
    s_mov_b32 exec_hi, 0
    buffer_store_dword v24, v25, s[52:55], s18 offen
    s_mov_b64 exec, 1
    buffer_store_dword v24, off, s[52:55], s19
    s_mov_b64 exec, -1
    ds_write_b32 v9, v9 offset:36
    s_branch Lhd_47
Lnl_46:
Lhd_47:
    buffer_load_dwordx4 v[20:23], v3, s[8:11], s67 offen
    s_setprio 0
Lw_48:
    ds_read_b32 v60, v9 offset:12
    s_sleep 1
    s_waitcnt lgkmcnt(0)
    v_readfirstlane_b32 s63, v60
    s_nop 0
    s_cmp_lg_u32 s63, 159744
    s_cbranch_scc1 Lw_48
    s_setprio 1
    buffer_load_dwordx4 v[88:91], v4, s[52:55], s15 offen offset:0 sc1
    buffer_load_dwordx4 v[92:95], v4, s[52:55], s15 offen offset:256 sc1
    s_addk_i32 s15, 8192
    s_cmp_eq_u32 s15, s13
    s_cselect_b32 s15, s12, s15
    buffer_load_dwordx4 v[96:99], v4, s[52:55], s15 offen offset:0 sc1
    buffer_load_dwordx4 v[100:103], v4, s[52:55], s15 offen offset:256 sc1
    s_addk_i32 s15, 8192
    s_cmp_eq_u32 s15, s13
    s_cselect_b32 s15, s12, s15
    buffer_load_dwordx4 v[104:107], v4, s[52:55], s15 offen offset:0 sc1
    buffer_load_dwordx4 v[108:111], v4, s[52:55], s15 offen offset:256 sc1
    s_addk_i32 s15, 8192
    s_cmp_eq_u32 s15, s13
    s_cselect_b32 s15, s12, s15
Lw_49:
    ds_read_b32 v60, v9 offset:16
    s_waitcnt lgkmcnt(0)
    v_readfirstlane_b32 s63, v60
    s_nop 0
    s_cmp_lg_u32 s63, 319488
    s_cbranch_scc1 Lw_49
    ds_read_b64_tr_b16 v[24:25], v13 offset:49152
    ds_read_b64_tr_b16 v[26:27], v13 offset:49664
    ds_read_b64_tr_b16 v[28:29], v14 offset:49152
    ds_read_b64_tr_b16 v[30:31], v14 offset:49664
    ds_read_b64_tr_b16 v[32:33], v15 offset:49152
    ds_read_b64_tr_b16 v[34:35], v15 offset:49664
    ds_read_b64_tr_b16 v[36:37], v8 offset:49152
    ds_read_b64_tr_b16 v[38:39], v8 offset:49664
    buffer_load_dwordx2 v[0:1], v7, s[52:55], s27 offen sc1
    ds_read_b64_tr_b16 v[40:41], v13 offset:32768
    ds_read_b64_tr_b16 v[42:43], v13 offset:33280
    ds_read_b64_tr_b16 v[44:45], v14 offset:32768
    ds_read_b64_tr_b16 v[46:47], v14 offset:33280
    ds_read_b64_tr_b16 v[48:49], v15 offset:32768
    ds_read_b64_tr_b16 v[50:51], v15 offset:33280
    ds_read_b64_tr_b16 v[52:53], v8 offset:32768
    ds_read_b64_tr_b16 v[54:55], v8 offset:33280
    s_waitcnt vmcnt(5)
    s_waitcnt lgkmcnt(8)
    v_mfma_f32_16x16x32_bf16 v[56:59], v[88:91], v[24:27], 0
    v_mfma_f32_16x16x32_bf16 v[60:63], v[88:91], v[28:31], 0
    v_mfma_f32_16x16x32_bf16 v[64:67], v[88:91], v[32:35], 0
    v_mfma_f32_16x16x32_bf16 v[68:71], v[88:91], v[36:39], 0
    buffer_load_dwordx4 v[112:115], v4, s[52:55], s15 offen offset:0 sc1
    v_mfma_f32_16x16x32_bf16 v[84:87], v[92:95], v[36:39], 0
    v_mfma_f32_16x16x32_bf16 v[80:83], v[92:95], v[32:35], 0
    v_mfma_f32_16x16x32_bf16 v[76:79], v[92:95], v[28:31], 0
    v_mfma_f32_16x16x32_bf16 v[72:75], v[92:95], v[24:27], 0
    buffer_load_dwordx4 v[116:119], v4, s[52:55], s15 offen offset:256 sc1
    s_addk_i32 s15, 8192
    s_cmp_eq_u32 s15, s13
    s_cselect_b32 s15, s12, s15
    ds_read_b64_tr_b16 v[24:25], v2 offset:0
    ds_read_b64_tr_b16 v[26:27], v2 offset:512
    ds_read_b64_tr_b16 v[28:29], v10 offset:0
    ds_read_b64_tr_b16 v[30:31], v10 offset:512
    ds_read_b64_tr_b16 v[32:33], v11 offset:0
    ds_read_b64_tr_b16 v[34:35], v11 offset:512
    ds_read_b64_tr_b16 v[36:37], v12 offset:0
    ds_read_b64_tr_b16 v[38:39], v12 offset:512
    s_waitcnt vmcnt(5)
    s_waitcnt lgkmcnt(8)
    v_mfma_f32_16x16x32_bf16 v[56:59], v[96:99], v[40:43], v[56:59]
    v_mfma_f32_16x16x32_bf16 v[60:63], v[96:99], v[44:47], v[60:63]
    v_mfma_f32_16x16x32_bf16 v[64:67], v[96:99], v[48:51], v[64:67]
    v_mfma_f32_16x16x32_bf16 v[68:71], v[96:99], v[52:55], v[68:71]
    buffer_load_dwordx4 v[120:123], v4, s[52:55], s15 offen offset:0 sc1
    v_mfma_f32_16x16x32_bf16 v[84:87], v[100:103], v[52:55], v[84:87]
    v_mfma_f32_16x16x32_bf16 v[80:83], v[100:103], v[48:51], v[80:83]
    v_mfma_f32_16x16x32_bf16 v[76:79], v[100:103], v[44:47], v[76:79]
    v_mfma_f32_16x16x32_bf16 v[72:75], v[100:103], v[40:43], v[72:75]
    buffer_load_dwordx4 v[124:127], v4, s[52:55], s15 offen offset:256 sc1
    s_addk_i32 s15, 8192
    s_cmp_eq_u32 s15, s13
    s_cselect_b32 s15, s12, s15
    ds_read_b64_tr_b16 v[40:41], v2 offset:16384
    ds_read_b64_tr_b16 v[42:43], v2 offset:16896
    ds_read_b64_tr_b16 v[44:45], v10 offset:16384
    ds_read_b64_tr_b16 v[46:47], v10 offset:16896
    ds_read_b64_tr_b16 v[48:49], v11 offset:16384
    ds_read_b64_tr_b16 v[50:51], v11 offset:16896
    ds_read_b64_tr_b16 v[52:53], v12 offset:16384
    ds_read_b64_tr_b16 v[54:55], v12 offset:16896
    s_waitcnt vmcnt(5)
    s_waitcnt lgkmcnt(8)
    v_mfma_f32_16x16x32_bf16 v[56:59], v[104:107], v[24:27], v[56:59]
    v_mfma_f32_16x16x32_bf16 v[60:63], v[104:107], v[28:31], v[60:63]
    v_mfma_f32_16x16x32_bf16 v[64:67], v[104:107], v[32:35], v[64:67]
    v_mfma_f32_16x16x32_bf16 v[68:71], v[104:107], v[36:39], v[68:71]
    buffer_load_dwordx4 v[88:91], v4, s[52:55], s15 offen offset:0 sc1
    v_mfma_f32_16x16x32_bf16 v[84:87], v[108:111], v[36:39], v[84:87]
    v_mfma_f32_16x16x32_bf16 v[80:83], v[108:111], v[32:35], v[80:83]
    v_mfma_f32_16x16x32_bf16 v[76:79], v[108:111], v[28:31], v[76:79]
    v_mfma_f32_16x16x32_bf16 v[72:75], v[108:111], v[24:27], v[72:75]
    buffer_load_dwordx4 v[92:95], v4, s[52:55], s15 offen offset:256 sc1
    s_addk_i32 s15, 8192
    s_cmp_eq_u32 s15, s13
    s_cselect_b32 s15, s12, s15
    ds_read_b64_tr_b16 v[24:25], v2 offset:32768
    ds_read_b64_tr_b16 v[26:27], v2 offset:33280
    ds_read_b64_tr_b16 v[28:29], v10 offset:32768
    ds_read_b64_tr_b16 v[30:31], v10 offset:33280
    ds_read_b64_tr_b16 v[32:33], v11 offset:32768
    ds_read_b64_tr_b16 v[34:35], v11 offset:33280
    ds_read_b64_tr_b16 v[36:37], v12 offset:32768
    ds_read_b64_tr_b16 v[38:39], v12 offset:33280
    s_waitcnt vmcnt(4)
    s_waitcnt lgkmcnt(8)
    v_mfma_f32_16x16x32_bf16 v[56:59], v[112:115], v[40:43], v[56:59]
    v_mfma_f32_16x16x32_bf16 v[60:63], v[112:115], v[44:47], v[60:63]
    v_mfma_f32_16x16x32_bf16 v[64:67], v[112:115], v[48:51], v[64:67]
    v_mfma_f32_16x16x32_bf16 v[68:71], v[112:115], v[52:55], v[68:71]
    buffer_load_dwordx4 v[96:99], v4, s[52:55], s15 offen offset:0 sc1
    v_mfma_f32_16x16x32_bf16 v[84:87], v[116:119], v[52:55], v[84:87]
    v_mfma_f32_16x16x32_bf16 v[80:83], v[116:119], v[48:51], v[80:83]
    v_mfma_f32_16x16x32_bf16 v[76:79], v[116:119], v[44:47], v[76:79]
    v_mfma_f32_16x16x32_bf16 v[72:75], v[116:119], v[40:43], v[72:75]
    buffer_load_dwordx4 v[100:103], v4, s[52:55], s15 offen offset:256 sc1
    s_addk_i32 s15, 8192
    s_cmp_eq_u32 s15, s13
    s_cselect_b32 s15, s12, s15
    ds_read_b64_tr_b16 v[40:41], v2 offset:49152
    ds_read_b64_tr_b16 v[42:43], v2 offset:49664
    ds_read_b64_tr_b16 v[44:45], v10 offset:49152
    ds_read_b64_tr_b16 v[46:47], v10 offset:49664
    ds_read_b64_tr_b16 v[48:49], v11 offset:49152
    ds_read_b64_tr_b16 v[50:51], v11 offset:49664
    ds_read_b64_tr_b16 v[52:53], v12 offset:49152
    ds_read_b64_tr_b16 v[54:55], v12 offset:49664
    s_waitcnt vmcnt(4)
    s_waitcnt lgkmcnt(8)
    v_mfma_f32_16x16x32_bf16 v[56:59], v[120:123], v[24:27], v[56:59]
    v_mfma_f32_16x16x32_bf16 v[60:63], v[120:123], v[28:31], v[60:63]
    v_mfma_f32_16x16x32_bf16 v[64:67], v[120:123], v[32:35], v[64:67]
    v_mfma_f32_16x16x32_bf16 v[68:71], v[120:123], v[36:39], v[68:71]
    buffer_load_dwordx4 v[104:107], v4, s[52:55], s15 offen offset:0 sc1
    v_mfma_f32_16x16x32_bf16 v[84:87], v[124:127], v[36:39], v[84:87]
    v_mfma_f32_16x16x32_bf16 v[80:83], v[124:127], v[32:35], v[80:83]
    v_mfma_f32_16x16x32_bf16 v[76:79], v[124:127], v[28:31], v[76:79]
    v_mfma_f32_16x16x32_bf16 v[72:75], v[124:127], v[24:27], v[72:75]
    buffer_load_dwordx4 v[108:111], v4, s[52:55], s15 offen offset:256 sc1
    s_addk_i32 s15, 8192
    s_cmp_eq_u32 s15, s13
    s_cselect_b32 s15, s12, s15
    s_barrier
    ds_read_b64_tr_b16 v[24:25], v13 offset:0
    ds_read_b64_tr_b16 v[26:27], v13 offset:512
    ds_read_b64_tr_b16 v[28:29], v14 offset:0
    ds_read_b64_tr_b16 v[30:31], v14 offset:512
    ds_read_b64_tr_b16 v[32:33], v15 offset:0
    ds_read_b64_tr_b16 v[34:35], v15 offset:512
    ds_read_b64_tr_b16 v[36:37], v8 offset:0
    ds_read_b64_tr_b16 v[38:39], v8 offset:512
    s_waitcnt vmcnt(4)
    s_waitcnt lgkmcnt(8)
    v_mfma_f32_16x16x32_bf16 v[56:59], v[88:91], v[40:43], v[56:59]
    v_mfma_f32_16x16x32_bf16 v[60:63], v[88:91], v[44:47], v[60:63]
    v_mfma_f32_16x16x32_bf16 v[64:67], v[88:91], v[48:51], v[64:67]
    v_mfma_f32_16x16x32_bf16 v[68:71], v[88:91], v[52:55], v[68:71]
    buffer_load_dwordx4 v[112:115], v4, s[52:55], s15 offen offset:0 sc1
    v_mfma_f32_16x16x32_bf16 v[84:87], v[92:95], v[52:55], v[84:87]
    v_mfma_f32_16x16x32_bf16 v[80:83], v[92:95], v[48:51], v[80:83]
    v_mfma_f32_16x16x32_bf16 v[76:79], v[92:95], v[44:47], v[76:79]
    v_mfma_f32_16x16x32_bf16 v[72:75], v[92:95], v[40:43], v[72:75]
    buffer_load_dwordx4 v[116:119], v4, s[52:55], s15 offen offset:256 sc1
    s_addk_i32 s15, 8192
    s_cmp_eq_u32 s15, s13
    s_cselect_b32 s15, s12, s15
    ds_read_b64_tr_b16 v[40:41], v13 offset:16384
    ds_read_b64_tr_b16 v[42:43], v13 offset:16896
    ds_read_b64_tr_b16 v[44:45], v14 offset:16384
    ds_read_b64_tr_b16 v[46:47], v14 offset:16896
    ds_read_b64_tr_b16 v[48:49], v15 offset:16384
    ds_read_b64_tr_b16 v[50:51], v15 offset:16896
    ds_read_b64_tr_b16 v[52:53], v8 offset:16384
    ds_read_b64_tr_b16 v[54:55], v8 offset:16896
    s_waitcnt vmcnt(4)
    s_waitcnt lgkmcnt(8)
    v_mfma_f32_16x16x32_bf16 v[56:59], v[96:99], v[24:27], v[56:59]
    v_mfma_f32_16x16x32_bf16 v[60:63], v[96:99], v[28:31], v[60:63]
    v_mfma_f32_16x16x32_bf16 v[64:67], v[96:99], v[32:35], v[64:67]
    v_mfma_f32_16x16x32_bf16 v[68:71], v[96:99], v[36:39], v[68:71]
    buffer_load_dwordx4 v[120:123], v4, s[52:55], s15 offen offset:0 sc1
    v_mfma_f32_16x16x32_bf16 v[84:87], v[100:103], v[36:39], v[84:87]
    v_mfma_f32_16x16x32_bf16 v[80:83], v[100:103], v[32:35], v[80:83]
    v_mfma_f32_16x16x32_bf16 v[76:79], v[100:103], v[28:31], v[76:79]
    v_mfma_f32_16x16x32_bf16 v[72:75], v[100:103], v[24:27], v[72:75]
    buffer_load_dwordx4 v[124:127], v4, s[52:55], s15 offen offset:256 sc1
    s_barrier
    v_add_u32 v2, 131072, v2
    v_add_u32 v10, 131072, v10
    v_add_u32 v11, 131072, v11
    v_add_u32 v12, 131072, v12
    ds_read_b64_tr_b16 v[24:25], v2 offset:0
    ds_read_b64_tr_b16 v[26:27], v2 offset:512
    ds_read_b64_tr_b16 v[28:29], v10 offset:0
    ds_read_b64_tr_b16 v[30:31], v10 offset:512
    ds_read_b64_tr_b16 v[32:33], v11 offset:0
    ds_read_b64_tr_b16 v[34:35], v11 offset:512
    ds_read_b64_tr_b16 v[36:37], v12 offset:0
    ds_read_b64_tr_b16 v[38:39], v12 offset:512
    s_waitcnt vmcnt(4)
    s_waitcnt lgkmcnt(8)
    v_mfma_f32_16x16x32_bf16 v[56:59], v[104:107], v[40:43], v[56:59]
    v_mfma_f32_16x16x32_bf16 v[60:63], v[104:107], v[44:47], v[60:63]
    v_mfma_f32_16x16x32_bf16 v[64:67], v[104:107], v[48:51], v[64:67]
    v_mfma_f32_16x16x32_bf16 v[68:71], v[104:107], v[52:55], v[68:71]
    buffer_load_dwordx4 v[88:91], v4, s[52:55], s14 offen offset:0 sc1
    v_mfma_f32_16x16x32_bf16 v[84:87], v[108:111], v[52:55], v[84:87]
    v_mfma_f32_16x16x32_bf16 v[80:83], v[108:111], v[48:51], v[80:83]
    v_mfma_f32_16x16x32_bf16 v[76:79], v[108:111], v[44:47], v[76:79]
    v_mfma_f32_16x16x32_bf16 v[72:75], v[108:111], v[40:43], v[72:75]
    buffer_load_dwordx4 v[92:95], v4, s[52:55], s14 offen offset:256 sc1
    v_lshlrev_b32 v96, 16, v20
    v_and_b32 v97, 0xffff0000, v20
    v_lshlrev_b32 v104, 16, v16
    v_and_b32 v105, 0xffff0000, v16
    v_lshlrev_b32 v98, 16, v21
    v_and_b32 v99, 0xffff0000, v21
    v_lshlrev_b32 v106, 16, v17
    v_and_b32 v107, 0xffff0000, v17
    v_lshlrev_b32 v100, 16, v22
    v_and_b32 v101, 0xffff0000, v22
    v_lshlrev_b32 v108, 16, v18
    v_and_b32 v109, 0xffff0000, v18
    v_lshlrev_b32 v102, 16, v23
    v_and_b32 v103, 0xffff0000, v23
    v_lshlrev_b32 v110, 16, v19
    v_and_b32 v111, 0xffff0000, v19
    v_mul_f32 v96, v0, v96
    v_mul_f32 v97, v0, v97
    v_mul_f32 v98, v0, v98
    v_mul_f32 v99, v0, v99
    v_mul_f32 v100, v0, v100
    v_mul_f32 v101, v0, v101
    v_mul_f32 v102, v0, v102
    v_mul_f32 v103, v0, v103
    ds_read_b64_tr_b16 v[40:41], v13 offset:49152
    ds_read_b64_tr_b16 v[42:43], v13 offset:49664
    ds_read_b64_tr_b16 v[44:45], v14 offset:49152
    ds_read_b64_tr_b16 v[46:47], v14 offset:49664
    ds_read_b64_tr_b16 v[48:49], v15 offset:49152
    ds_read_b64_tr_b16 v[50:51], v15 offset:49664
    ds_read_b64_tr_b16 v[52:53], v8 offset:49152
    ds_read_b64_tr_b16 v[54:55], v8 offset:49664
    s_waitcnt vmcnt(4)
    s_waitcnt lgkmcnt(8)
    v_mfma_f32_16x16x32_bf16 v[56:59], v[112:115], v[24:27], v[56:59]
    v_mfma_f32_16x16x32_bf16 v[60:63], v[112:115], v[28:31], v[60:63]
    v_mfma_f32_16x16x32_bf16 v[64:67], v[112:115], v[32:35], v[64:67]
    v_mfma_f32_16x16x32_bf16 v[68:71], v[112:115], v[36:39], v[68:71]
    v_mfma_f32_16x16x32_bf16 v[84:87], v[116:119], v[36:39], v[84:87]
    v_mfma_f32_16x16x32_bf16 v[80:83], v[116:119], v[32:35], v[80:83]
    v_mfma_f32_16x16x32_bf16 v[76:79], v[116:119], v[28:31], v[76:79]
    v_mfma_f32_16x16x32_bf16 v[72:75], v[116:119], v[24:27], v[72:75]
    ds_read_b64_tr_b16 v[24:25], v2 offset:16384
    ds_read_b64_tr_b16 v[26:27], v2 offset:16896
    ds_read_b64_tr_b16 v[28:29], v10 offset:16384
    ds_read_b64_tr_b16 v[30:31], v10 offset:16896
    ds_read_b64_tr_b16 v[32:33], v11 offset:16384
    ds_read_b64_tr_b16 v[34:35], v11 offset:16896
    ds_read_b64_tr_b16 v[36:37], v12 offset:16384
    ds_read_b64_tr_b16 v[38:39], v12 offset:16896
    s_waitcnt vmcnt(2)
    s_waitcnt lgkmcnt(8)
    v_mfma_f32_16x16x32_bf16 v[56:59], v[120:123], v[40:43], v[56:59]
    v_mfma_f32_16x16x32_bf16 v[60:63], v[120:123], v[44:47], v[60:63]
    v_mfma_f32_16x16x32_bf16 v[64:67], v[120:123], v[48:51], v[64:67]
    v_mfma_f32_16x16x32_bf16 v[68:71], v[120:123], v[52:55], v[68:71]
    v_mfma_f32_16x16x32_bf16 v[84:87], v[124:127], v[52:55], v[84:87]
    v_mfma_f32_16x16x32_bf16 v[80:83], v[124:127], v[48:51], v[80:83]
    v_mfma_f32_16x16x32_bf16 v[76:79], v[124:127], v[44:47], v[76:79]
    v_mfma_f32_16x16x32_bf16 v[72:75], v[124:127], v[40:43], v[72:75]
    s_cmp_eq_u32 s25, 3
    s_cbranch_scc1 L_no10
    s_waitcnt vmcnt(0)
    s_waitcnt lgkmcnt(0)
    v_mfma_f32_16x16x32_bf16 v[56:59], v[88:91], v[24:27], v[56:59]
    v_mfma_f32_16x16x32_bf16 v[60:63], v[88:91], v[28:31], v[60:63]
    v_mfma_f32_16x16x32_bf16 v[64:67], v[88:91], v[32:35], v[64:67]
    v_mfma_f32_16x16x32_bf16 v[68:71], v[88:91], v[36:39], v[68:71]
    v_mfma_f32_16x16x32_bf16 v[84:87], v[92:95], v[36:39], v[84:87]
    v_mfma_f32_16x16x32_bf16 v[80:83], v[92:95], v[32:35], v[80:83]
    v_mfma_f32_16x16x32_bf16 v[76:79], v[92:95], v[28:31], v[76:79]
    v_mfma_f32_16x16x32_bf16 v[72:75], v[92:95], v[24:27], v[72:75]
L_no10:
    s_nop 4
    ds_write_addtid_b32 v56 offset:0
    ds_write_addtid_b32 v57 offset:1040
    ds_write_addtid_b32 v58 offset:4224
    ds_write_addtid_b32 v59 offset:5264
    ds_write_addtid_b32 v60 offset:2112
    ds_write_addtid_b32 v61 offset:3152
    ds_write_addtid_b32 v62 offset:6336
    ds_write_addtid_b32 v63 offset:7376
    ds_write_addtid_b32 v64 offset:256
    ds_write_addtid_b32 v65 offset:1296
    ds_write_addtid_b32 v66 offset:4480
    ds_write_addtid_b32 v67 offset:5520
    ds_write_addtid_b32 v68 offset:2368
    ds_write_addtid_b32 v69 offset:3408
    ds_write_addtid_b32 v70 offset:6592
    ds_write_addtid_b32 v71 offset:7632
    ds_write_addtid_b32 v72 offset:512
    ds_write_addtid_b32 v73 offset:1552
    ds_write_addtid_b32 v74 offset:4736
    ds_write_addtid_b32 v75 offset:5776
    ds_write_addtid_b32 v76 offset:2624
    ds_write_addtid_b32 v77 offset:3664
    ds_write_addtid_b32 v78 offset:6848
    ds_write_addtid_b32 v79 offset:7888
    ds_write_addtid_b32 v80 offset:768
    ds_write_addtid_b32 v81 offset:1808
    ds_write_addtid_b32 v82 offset:4992
    ds_write_addtid_b32 v83 offset:6032
    ds_write_addtid_b32 v84 offset:2880
    ds_write_addtid_b32 v85 offset:3920
    ds_write_addtid_b32 v86 offset:7104
    ds_write_addtid_b32 v87 offset:8144
    s_waitcnt vmcnt(0) lgkmcnt(0)
    s_barrier
    ds_read_b128 v[112:115], v6
    ds_read_b128 v[24:27], v5 offset:0
    ds_read_b128 v[28:31], v5 offset:16
    ds_read_b128 v[32:35], v5 offset:16896
    ds_read_b128 v[36:39], v5 offset:16912
    ds_read_b128 v[40:43], v5 offset:33792
    ds_read_b128 v[44:47], v5 offset:33808
    ds_read_b128 v[48:51], v5 offset:50688
    ds_read_b128 v[52:55], v5 offset:50704
    s_waitcnt lgkmcnt(8)
    v_lshlrev_b32 v116, 16, v112
    v_and_b32 v117, 0xffff0000, v112
    v_lshlrev_b32 v118, 16, v113
    v_and_b32 v119, 0xffff0000, v113
    v_lshlrev_b32 v120, 16, v114
    v_and_b32 v121, 0xffff0000, v114
    v_lshlrev_b32 v122, 16, v115
    v_and_b32 v123, 0xffff0000, v115
    v_pk_mul_f32 v[96:97], v[96:97], v[116:117]
    v_pk_mul_f32 v[98:99], v[98:99], v[118:119]
    v_pk_mul_f32 v[100:101], v[100:101], v[120:121]
    v_pk_mul_f32 v[102:103], v[102:103], v[122:123]
    s_waitcnt lgkmcnt(6)
    v_pk_add_f32 v[104:105], v[104:105], v[24:25]
    v_pk_add_f32 v[106:107], v[106:107], v[26:27]
    v_pk_add_f32 v[108:109], v[108:109], v[28:29]
    v_pk_add_f32 v[110:111], v[110:111], v[30:31]
    s_waitcnt lgkmcnt(4)
    v_pk_add_f32 v[104:105], v[104:105], v[32:33]
    v_pk_add_f32 v[106:107], v[106:107], v[34:35]
    v_pk_add_f32 v[108:109], v[108:109], v[36:37]
    v_pk_add_f32 v[110:111], v[110:111], v[38:39]
    s_waitcnt lgkmcnt(2)
    v_pk_add_f32 v[104:105], v[104:105], v[40:41]
    v_pk_add_f32 v[106:107], v[106:107], v[42:43]
    v_pk_add_f32 v[108:109], v[108:109], v[44:45]
    v_pk_add_f32 v[110:111], v[110:111], v[46:47]
    s_waitcnt lgkmcnt(0)
    v_pk_add_f32 v[104:105], v[104:105], v[48:49]
    v_pk_add_f32 v[106:107], v[106:107], v[50:51]
    v_pk_add_f32 v[108:109], v[108:109], v[52:53]
    v_pk_add_f32 v[110:111], v[110:111], v[54:55]
    v_pk_fma_f32 v[96:97], v[104:105], v[0:1], v[96:97] op_sel:[0,1,0] op_sel_hi:[1,1,1]
    v_pk_fma_f32 v[98:99], v[106:107], v[0:1], v[98:99] op_sel:[0,1,0] op_sel_hi:[1,1,1]
    v_pk_fma_f32 v[100:101], v[108:109], v[0:1], v[100:101] op_sel:[0,1,0] op_sel_hi:[1,1,1]
    v_pk_fma_f32 v[102:103], v[110:111], v[0:1], v[102:103] op_sel:[0,1,0] op_sel_hi:[1,1,1]
    v_cvt_pk_bf16_f32 v124, v96, v97
    v_cvt_pk_bf16_f32 v125, v98, v99
    v_cvt_pk_bf16_f32 v126, v100, v101
    v_cvt_pk_bf16_f32 v127, v102, v103
    buffer_store_dwordx4 v[124:127], v3, s[48:51], s67 offen
    s_endpgm
L_gwg:
    s_barrier
    s_setprio 0
Lw_50:
    ds_read_b32 v14, v9 offset:4
    s_sleep 1
    s_waitcnt lgkmcnt(0)
    v_readfirstlane_b32 s63, v14
    s_nop 0
    s_cmp_lg_u32 s63, 958464
    s_cbranch_scc1 Lw_50
    s_mov_b64 exec, 1
    ds_add_u32 v9, v9 offset:8
    s_mov_b64 exec, -1
    s_branch L_join
L_codeend:
L_end:
    s_endpgm

.section .rodata,"a"
.p2align 6
.amdhsa_kernel gated_mix__ssm_conv_h3__dense_activation_gelu__prompt_kernel
  .amdhsa_next_free_vgpr 128
  .amdhsa_next_free_sgpr 102
  .amdhsa_accum_offset 128
  .amdhsa_group_segment_fixed_size 0
  .amdhsa_kernarg_size 120
  .amdhsa_user_sgpr_count 2
  .amdhsa_user_sgpr_kernarg_segment_ptr 1
  .amdhsa_system_sgpr_workgroup_id_x 1
  .amdhsa_float_denorm_mode_32 3
.end_amdhsa_kernel
```
